```python
import torch

def _softmax(x, axis=-1):
    return torch.softmax(x, dim=axis)
def _gelu(x):
    return torch.nn.functional.gelu(x, approximate="tanh")
def _silu(x):
    return torch.nn.functional.silu(x)
def _sigmoid(x):
    return torch.sigmoid(x)
def _layernorm(x, axis=-1, eps=1e-5):
    m = x.mean(dim=axis, keepdim=True)
    v = x.var(dim=axis, keepdim=True, unbiased=False)
    return (x - m) / torch.sqrt(v + eps)
def _scatter_add(tgt, idx, src, axis=0):
    return tgt.clone().index_add_(axis, idx, src)
def _segment_sum(src, seg, n):
    out = torch.zeros((n,) + src.shape[1:], dtype=src.dtype)
    return out.index_add_(0, seg, src)
def _pad(x, pw):
    flat = tuple(v for pair in reversed(pw) for v in pair)
    return torch.nn.functional.pad(x, flat)

kernel_name = 'standalone__gqa_block_cached__near_ridge'

def setup_inputs():

    _w = (lambda a: (lambda t: t.to(torch.bfloat16) if t.is_floating_point() else t)(torch.as_tensor(a)))
    B, Sq, D = 8, 128, 512
    Hq, Hkv, Sk, Dh = 32, 32, 2048, 128
    assert Hq % Hkv == 0, (Hq, Hkv)
    return {
        "x": _w((lambda *s: torch.randn(*s, dtype=torch.bfloat16) * 0.8)(B, Sq, D)),
        "k_cache": _w((lambda *s: torch.randn(*s, dtype=torch.bfloat16) * 0.8)(B, Hkv, Sk, Dh)),
        "v_cache": _w((lambda *s: torch.randn(*s, dtype=torch.bfloat16) * 0.05)(B, Hkv, Sk, Dh)),
        "wq": _w((lambda *s: torch.randn(*s, dtype=torch.bfloat16) * 0.8)(D, Hq * Dh) * (D ** -0.5)),
        "wo": _w((lambda *s: torch.randn(*s, dtype=torch.bfloat16) * 0.05)(Hq * Dh, D) * ((Hq * Dh) ** -0.5)),
    }

def reference(x, k_cache, v_cache, wq, wo):
    B, Sq, D = x.shape
    Hq, Dh = 32, 128
    Hkv = k_cache.shape[1]
    rep = Hq // Hkv
    q = (lambda x, *d: x.permute(*d))((x @ wq).reshape(B, Sq, Hq, Dh), 0, 2, 1, 3)
    k = (lambda x, n, axis: torch.repeat_interleave(x, n, dim=axis))(k_cache, rep, axis=1)
    v = (lambda x, n, axis: torch.repeat_interleave(x, n, dim=axis))(v_cache, rep, axis=1)
    scores = torch.einsum("bhqd,bhkd->bhqk", q, k) * (Dh ** -0.5)
    p = _softmax(scores, axis=-1)
    o = torch.einsum("bhqk,bhkd->bhqd", p, v)
    return (lambda x, *d: x.permute(*d))(o, 0, 2, 1, 3).reshape(B, Sq, Hq * Dh) @ wo
```

```asm
; @launch kernel=attn_kernel grid=(256,1,1) block=(512,1,1) lds=163840
; @launch kernel=oproj_kernel grid=(256,1,1) block=(256,1,1) lds=131072
.amdgcn_target "amdgcn-amd-amdhsa--gfx950"
.text
.globl attn_kernel
.p2align 8
.type attn_kernel,@function
attn_kernel:
s_cmp_ge_u32 s2, 256
s_cbranch_scc1 A_end
s_load_dwordx8 s[4:11], s[0:1], 0
s_load_dwordx2 s[12:13], s[0:1], 56
s_waitcnt lgkmcnt(0)
s_mov_b32 s16, s4
s_mov_b32 s17, s5
s_mov_b32 s18, 1048576
s_mov_b32 s19, 0x00020000
s_mov_b32 s20, s6
s_mov_b32 s21, s7
s_mov_b32 s22, 134217728
s_mov_b32 s23, 0x00020000
s_mov_b32 s24, s8
s_mov_b32 s25, s9
s_mov_b32 s26, 134217728
s_mov_b32 s27, 0x00020000
s_mov_b32 s28, s10
s_mov_b32 s29, s11
s_mov_b32 s30, 4194304
s_mov_b32 s31, 0x00020000
s_mov_b32 s32, s12
s_mov_b32 s33, s13
s_mov_b32 s34, 8388608
s_mov_b32 s35, 0x00020000
v_and_b32 v1, 63, v0
v_lshrrev_b32 v2, 6, v0
s_nop 0
v_readfirstlane_b32 s40, v2
s_nop 3
s_lshr_b32 s41, s40, 2
s_and_b32 s42, s40, 3
s_lshl_b32 s43, s2, 19
s_lshr_b32 s44, s2, 5
s_and_b32 s45, s2, 31
v_lshrrev_b32 v3, 4, v1
v_and_b32 v4, 15, v1
s_lshl_b32 s46, s40, 2
v_add_u32 v5, s46, v3
v_and_b32 v6, 15, v5
v_xor_b32 v6, v6, v4
v_lshlrev_b32 v7, 8, v5
v_lshl_add_u32 v200, v6, 4, v7
v_lshlrev_b32 v6, 2, v3
v_xor_b32 v6, v6, v4
v_lshl_add_u32 v201, v6, 4, v7
v_lshlrev_b32 v7, 13, v5
v_lshl_add_u32 v202, v6, 4, v7
s_lshl_b32 s47, s40, 10
s_mul_i32 s62, s2, 5
v_and_b32 v8, 31, v1
v_lshrrev_b32 v9, 5, v1
s_lshl_b32 s54, s44, 7
s_lshl_b32 s55, s42, 5
s_add_u32 s54, s54, s55
v_add_u32 v10, s54, v8
v_lshlrev_b32 v10, 10, v10
v_lshl_add_u32 v203, v9, 4, v10
v_and_b32 v11, 3, v1
v_bfe_u32 v12, v1, 2, 2
v_bfe_u32 v13, v1, 4, 1
v_and_b32 v14, 1, v11
v_lshrrev_b32 v15, 1, v11
v_lshl_add_u32 v204, v13, 1, v14
v_lshlrev_b32 v205, 2, v12
v_xor_b32 v204, v204, v205
v_lshlrev_b32 v204, 4, v204
v_lshl_add_u32 v204, v15, 3, v204
v_lshl_add_u32 v205, v9, 3, v12
v_lshl_add_u32 v204, v205, 8, v204
s_lshl_b32 s55, s41, 7
v_xor_b32 v204, s55, v204
v_add_u32 v204, 0x18000, v204
v_xor_b32 v205, 64, v204
v_lshl_add_u32 v206, v13, 1, v15
v_lshlrev_b32 v207, 2, v12
v_xor_b32 v206, v206, v207
v_lshlrev_b32 v206, 4, v206
v_lshl_add_u32 v206, v14, 3, v206
v_lshl_add_u32 v207, v9, 2, v12
s_lshl_b32 s55, s41, 5
v_add_u32 v207, s55, v207
v_lshl_add_u32 v206, v207, 8, v206
v_add_u32 v206, 16384, v206
v_add_u32 v207, s55, v8
v_and_b32 v208, 15, v207
v_xor_b32 v208, v208, v9
v_lshlrev_b32 v208, 4, v208
v_lshl_add_u32 v207, v207, 8, v208
v_mov_b32 v208, 0
v_mov_b32 v209, 0
v_mov_b32 v210, 0
v_mov_b32 v211, 0
v_mov_b32 v212, 0
v_mov_b32 v213, 0
v_mov_b32 v214, 0
v_mov_b32 v215, 0
v_mov_b32 v216, 0
v_mov_b32 v217, 0
v_mov_b32 v218, 0
v_mov_b32 v219, 0
v_mov_b32 v220, 0
v_mov_b32 v221, 0
v_mov_b32 v222, 0
v_mov_b32 v223, 0
v_mov_b32 v224, 0
v_mov_b32 v225, 0
v_mov_b32 v226, 0
v_mov_b32 v227, 0
v_mov_b32 v228, 0
v_mov_b32 v229, 0
v_mov_b32 v230, 0
v_mov_b32 v231, 0
v_mov_b32 v232, 0
v_mov_b32 v233, 0
v_mov_b32 v234, 0
v_mov_b32 v235, 0
v_mov_b32 v236, 0
v_mov_b32 v237, 0
v_mov_b32 v238, 0
v_mov_b32 v239, 0
s_add_u32 s50, s47, 98304
s_lshl_b32 s51, s45, 8
s_add_u32 s51, s51, 0
s_mov_b32 m0, s50
s_nop 0
buffer_load_dwordx4 v202, s[28:31], s51 offen lds
s_add_u32 s50, s47, 106496
s_lshl_b32 s51, s45, 8
s_add_u32 s51, s51, 262144
s_mov_b32 m0, s50
s_nop 0
buffer_load_dwordx4 v202, s[28:31], s51 offen lds
s_add_u32 s50, s47, 114688
s_lshl_b32 s51, s45, 8
s_add_u32 s51, s51, 524288
s_mov_b32 m0, s50
s_nop 0
buffer_load_dwordx4 v202, s[28:31], s51 offen lds
s_add_u32 s50, s47, 122880
s_lshl_b32 s51, s45, 8
s_add_u32 s51, s51, 786432
s_mov_b32 m0, s50
s_nop 0
buffer_load_dwordx4 v202, s[28:31], s51 offen lds
s_add_u32 s50, s47, 131072
s_lshl_b32 s51, s45, 8
s_add_u32 s51, s51, 1048576
s_mov_b32 m0, s50
s_nop 0
buffer_load_dwordx4 v202, s[28:31], s51 offen lds
s_add_u32 s50, s47, 139264
s_lshl_b32 s51, s45, 8
s_add_u32 s51, s51, 1310720
s_mov_b32 m0, s50
s_nop 0
buffer_load_dwordx4 v202, s[28:31], s51 offen lds
s_add_u32 s50, s47, 147456
s_lshl_b32 s51, s45, 8
s_add_u32 s51, s51, 1572864
s_mov_b32 m0, s50
s_nop 0
buffer_load_dwordx4 v202, s[28:31], s51 offen lds
s_add_u32 s50, s47, 155648
s_lshl_b32 s51, s45, 8
s_add_u32 s51, s51, 1835008
s_mov_b32 m0, s50
s_nop 0
buffer_load_dwordx4 v202, s[28:31], s51 offen lds
buffer_load_dwordx4 v[48:51], v203, s[16:19], 0 offen offset:0
buffer_load_dwordx4 v[52:55], v203, s[16:19], 0 offen offset:32
buffer_load_dwordx4 v[56:59], v203, s[16:19], 0 offen offset:64
buffer_load_dwordx4 v[60:63], v203, s[16:19], 0 offen offset:96
buffer_load_dwordx4 v[64:67], v203, s[16:19], 0 offen offset:128
buffer_load_dwordx4 v[68:71], v203, s[16:19], 0 offen offset:160
buffer_load_dwordx4 v[72:75], v203, s[16:19], 0 offen offset:192
buffer_load_dwordx4 v[76:79], v203, s[16:19], 0 offen offset:224
buffer_load_dwordx4 v[80:83], v203, s[16:19], 0 offen offset:256
buffer_load_dwordx4 v[84:87], v203, s[16:19], 0 offen offset:288
buffer_load_dwordx4 v[88:91], v203, s[16:19], 0 offen offset:320
buffer_load_dwordx4 v[92:95], v203, s[16:19], 0 offen offset:352
buffer_load_dwordx4 v[96:99], v203, s[16:19], 0 offen offset:384
buffer_load_dwordx4 v[100:103], v203, s[16:19], 0 offen offset:416
buffer_load_dwordx4 v[104:107], v203, s[16:19], 0 offen offset:448
buffer_load_dwordx4 v[108:111], v203, s[16:19], 0 offen offset:480
s_add_u32 s52, s62, 0
s_and_b32 s52, s52, 31
s_lshl_b32 s52, s52, 14
s_add_u32 s52, s52, s43
s_mov_b32 s53, 0
s_add_u32 s50, s53, s47
s_add_u32 s50, s50, 0
s_add_u32 s51, s52, 0
s_mov_b32 m0, s50
s_nop 0
buffer_load_dwordx4 v200, s[20:23], s51 offen nt lds
s_add_u32 s50, s53, s47
s_add_u32 s50, s50, 8192
s_add_u32 s51, s52, 8192
s_mov_b32 m0, s50
s_nop 0
buffer_load_dwordx4 v200, s[20:23], s51 offen nt lds
s_add_u32 s50, s53, s47
s_add_u32 s50, s50, 16384
s_add_u32 s51, s52, 0
s_mov_b32 m0, s50
s_nop 0
buffer_load_dwordx4 v201, s[24:27], s51 offen nt lds
s_add_u32 s50, s53, s47
s_add_u32 s50, s50, 24576
s_add_u32 s51, s52, 8192
s_mov_b32 m0, s50
s_nop 0
buffer_load_dwordx4 v201, s[24:27], s51 offen nt lds
s_add_u32 s52, s62, 1
s_and_b32 s52, s52, 31
s_lshl_b32 s52, s52, 14
s_add_u32 s52, s52, s43
s_mov_b32 s53, 32768
s_add_u32 s50, s53, s47
s_add_u32 s50, s50, 0
s_add_u32 s51, s52, 0
s_mov_b32 m0, s50
s_nop 0
buffer_load_dwordx4 v200, s[20:23], s51 offen nt lds
s_add_u32 s50, s53, s47
s_add_u32 s50, s50, 8192
s_add_u32 s51, s52, 8192
s_mov_b32 m0, s50
s_nop 0
buffer_load_dwordx4 v200, s[20:23], s51 offen nt lds
s_add_u32 s50, s53, s47
s_add_u32 s50, s50, 16384
s_add_u32 s51, s52, 0
s_mov_b32 m0, s50
s_nop 0
buffer_load_dwordx4 v201, s[24:27], s51 offen nt lds
s_add_u32 s50, s53, s47
s_add_u32 s50, s50, 24576
s_add_u32 s51, s52, 8192
s_mov_b32 m0, s50
s_nop 0
buffer_load_dwordx4 v201, s[24:27], s51 offen nt lds
s_add_u32 s52, s62, 2
s_and_b32 s52, s52, 31
s_lshl_b32 s52, s52, 14
s_add_u32 s52, s52, s43
s_mov_b32 s53, 65536
s_add_u32 s50, s53, s47
s_add_u32 s50, s50, 0
s_add_u32 s51, s52, 0
s_mov_b32 m0, s50
s_nop 0
buffer_load_dwordx4 v200, s[20:23], s51 offen nt lds
s_add_u32 s50, s53, s47
s_add_u32 s50, s50, 8192
s_add_u32 s51, s52, 8192
s_mov_b32 m0, s50
s_nop 0
buffer_load_dwordx4 v200, s[20:23], s51 offen nt lds
s_add_u32 s50, s53, s47
s_add_u32 s50, s50, 16384
s_add_u32 s51, s52, 0
s_mov_b32 m0, s50
s_nop 0
buffer_load_dwordx4 v201, s[24:27], s51 offen nt lds
s_add_u32 s50, s53, s47
s_add_u32 s50, s50, 24576
s_add_u32 s51, s52, 8192
s_mov_b32 m0, s50
s_nop 0
buffer_load_dwordx4 v201, s[24:27], s51 offen nt lds
s_waitcnt vmcnt(12)
s_barrier
ds_read_b64_tr_b16 v[128:129], v204 offset:0
ds_read_b64_tr_b16 v[130:131], v204 offset:1024
ds_read_b64_tr_b16 v[132:133], v205 offset:0
ds_read_b64_tr_b16 v[134:135], v205 offset:1024
ds_read_b64_tr_b16 v[136:137], v204 offset:4096
ds_read_b64_tr_b16 v[138:139], v204 offset:5120
ds_read_b64_tr_b16 v[140:141], v205 offset:4096
ds_read_b64_tr_b16 v[142:143], v205 offset:5120
ds_read_b64_tr_b16 v[144:145], v204 offset:8192
ds_read_b64_tr_b16 v[146:147], v204 offset:9216
s_waitcnt lgkmcnt(8)
v_mfma_f32_32x32x16_bf16 v[208:223], v[128:131], v[48:51], v[208:223]
ds_read_b64_tr_b16 v[148:149], v205 offset:8192
ds_read_b64_tr_b16 v[150:151], v205 offset:9216
s_waitcnt lgkmcnt(8)
v_mfma_f32_32x32x16_bf16 v[224:239], v[132:135], v[48:51], v[224:239]
ds_read_b64_tr_b16 v[152:153], v204 offset:12288
ds_read_b64_tr_b16 v[154:155], v204 offset:13312
s_waitcnt lgkmcnt(8)
v_mfma_f32_32x32x16_bf16 v[208:223], v[136:139], v[52:55], v[208:223]
ds_read_b64_tr_b16 v[156:157], v205 offset:12288
ds_read_b64_tr_b16 v[158:159], v205 offset:13312
s_waitcnt lgkmcnt(8)
v_mfma_f32_32x32x16_bf16 v[224:239], v[140:143], v[52:55], v[224:239]
ds_read_b64_tr_b16 v[128:129], v204 offset:16384
ds_read_b64_tr_b16 v[130:131], v204 offset:17408
s_waitcnt lgkmcnt(8)
v_mfma_f32_32x32x16_bf16 v[208:223], v[144:147], v[56:59], v[208:223]
ds_read_b64_tr_b16 v[132:133], v205 offset:16384
ds_read_b64_tr_b16 v[134:135], v205 offset:17408
s_waitcnt lgkmcnt(8)
v_mfma_f32_32x32x16_bf16 v[224:239], v[148:151], v[56:59], v[224:239]
ds_read_b64_tr_b16 v[136:137], v204 offset:20480
ds_read_b64_tr_b16 v[138:139], v204 offset:21504
s_waitcnt lgkmcnt(8)
v_mfma_f32_32x32x16_bf16 v[208:223], v[152:155], v[60:63], v[208:223]
ds_read_b64_tr_b16 v[140:141], v205 offset:20480
ds_read_b64_tr_b16 v[142:143], v205 offset:21504
s_waitcnt lgkmcnt(8)
v_mfma_f32_32x32x16_bf16 v[224:239], v[156:159], v[60:63], v[224:239]
ds_read_b64_tr_b16 v[144:145], v204 offset:24576
ds_read_b64_tr_b16 v[146:147], v204 offset:25600
s_waitcnt lgkmcnt(8)
v_mfma_f32_32x32x16_bf16 v[208:223], v[128:131], v[64:67], v[208:223]
ds_read_b64_tr_b16 v[148:149], v205 offset:24576
ds_read_b64_tr_b16 v[150:151], v205 offset:25600
s_waitcnt lgkmcnt(8)
v_mfma_f32_32x32x16_bf16 v[224:239], v[132:135], v[64:67], v[224:239]
ds_read_b64_tr_b16 v[152:153], v204 offset:28672
ds_read_b64_tr_b16 v[154:155], v204 offset:29696
s_waitcnt lgkmcnt(8)
v_mfma_f32_32x32x16_bf16 v[208:223], v[136:139], v[68:71], v[208:223]
ds_read_b64_tr_b16 v[156:157], v205 offset:28672
ds_read_b64_tr_b16 v[158:159], v205 offset:29696
s_waitcnt lgkmcnt(8)
v_mfma_f32_32x32x16_bf16 v[224:239], v[140:143], v[68:71], v[224:239]
ds_read_b64_tr_b16 v[128:129], v204 offset:32768
ds_read_b64_tr_b16 v[130:131], v204 offset:33792
s_waitcnt lgkmcnt(8)
v_mfma_f32_32x32x16_bf16 v[208:223], v[144:147], v[72:75], v[208:223]
ds_read_b64_tr_b16 v[132:133], v205 offset:32768
ds_read_b64_tr_b16 v[134:135], v205 offset:33792
s_waitcnt lgkmcnt(8)
v_mfma_f32_32x32x16_bf16 v[224:239], v[148:151], v[72:75], v[224:239]
ds_read_b64_tr_b16 v[136:137], v204 offset:36864
ds_read_b64_tr_b16 v[138:139], v204 offset:37888
s_waitcnt lgkmcnt(8)
v_mfma_f32_32x32x16_bf16 v[208:223], v[152:155], v[76:79], v[208:223]
ds_read_b64_tr_b16 v[140:141], v205 offset:36864
ds_read_b64_tr_b16 v[142:143], v205 offset:37888
s_waitcnt lgkmcnt(8)
v_mfma_f32_32x32x16_bf16 v[224:239], v[156:159], v[76:79], v[224:239]
ds_read_b64_tr_b16 v[144:145], v204 offset:40960
ds_read_b64_tr_b16 v[146:147], v204 offset:41984
s_waitcnt lgkmcnt(8)
v_mfma_f32_32x32x16_bf16 v[208:223], v[128:131], v[80:83], v[208:223]
ds_read_b64_tr_b16 v[148:149], v205 offset:40960
ds_read_b64_tr_b16 v[150:151], v205 offset:41984
s_waitcnt lgkmcnt(8)
v_mfma_f32_32x32x16_bf16 v[224:239], v[132:135], v[80:83], v[224:239]
ds_read_b64_tr_b16 v[152:153], v204 offset:45056
ds_read_b64_tr_b16 v[154:155], v204 offset:46080
s_waitcnt lgkmcnt(8)
v_mfma_f32_32x32x16_bf16 v[208:223], v[136:139], v[84:87], v[208:223]
ds_read_b64_tr_b16 v[156:157], v205 offset:45056
ds_read_b64_tr_b16 v[158:159], v205 offset:46080
s_waitcnt lgkmcnt(8)
v_mfma_f32_32x32x16_bf16 v[224:239], v[140:143], v[84:87], v[224:239]
ds_read_b64_tr_b16 v[128:129], v204 offset:49152
ds_read_b64_tr_b16 v[130:131], v204 offset:50176
s_waitcnt lgkmcnt(8)
v_mfma_f32_32x32x16_bf16 v[208:223], v[144:147], v[88:91], v[208:223]
ds_read_b64_tr_b16 v[132:133], v205 offset:49152
ds_read_b64_tr_b16 v[134:135], v205 offset:50176
s_waitcnt lgkmcnt(8)
v_mfma_f32_32x32x16_bf16 v[224:239], v[148:151], v[88:91], v[224:239]
ds_read_b64_tr_b16 v[136:137], v204 offset:53248
ds_read_b64_tr_b16 v[138:139], v204 offset:54272
s_waitcnt lgkmcnt(8)
v_mfma_f32_32x32x16_bf16 v[208:223], v[152:155], v[92:95], v[208:223]
ds_read_b64_tr_b16 v[140:141], v205 offset:53248
ds_read_b64_tr_b16 v[142:143], v205 offset:54272
s_waitcnt lgkmcnt(8)
v_mfma_f32_32x32x16_bf16 v[224:239], v[156:159], v[92:95], v[224:239]
ds_read_b64_tr_b16 v[144:145], v204 offset:57344
ds_read_b64_tr_b16 v[146:147], v204 offset:58368
s_waitcnt lgkmcnt(8)
v_mfma_f32_32x32x16_bf16 v[208:223], v[128:131], v[96:99], v[208:223]
ds_read_b64_tr_b16 v[148:149], v205 offset:57344
ds_read_b64_tr_b16 v[150:151], v205 offset:58368
s_waitcnt lgkmcnt(8)
v_mfma_f32_32x32x16_bf16 v[224:239], v[132:135], v[96:99], v[224:239]
ds_read_b64_tr_b16 v[152:153], v204 offset:61440
ds_read_b64_tr_b16 v[154:155], v204 offset:62464
s_waitcnt lgkmcnt(8)
v_mfma_f32_32x32x16_bf16 v[208:223], v[136:139], v[100:103], v[208:223]
ds_read_b64_tr_b16 v[156:157], v205 offset:61440
ds_read_b64_tr_b16 v[158:159], v205 offset:62464
s_waitcnt lgkmcnt(8)
v_mfma_f32_32x32x16_bf16 v[224:239], v[140:143], v[100:103], v[224:239]
s_waitcnt lgkmcnt(6)
v_mfma_f32_32x32x16_bf16 v[208:223], v[144:147], v[104:107], v[208:223]
s_waitcnt lgkmcnt(4)
v_mfma_f32_32x32x16_bf16 v[224:239], v[148:151], v[104:107], v[224:239]
s_waitcnt lgkmcnt(2)
v_mfma_f32_32x32x16_bf16 v[208:223], v[152:155], v[108:111], v[208:223]
s_waitcnt lgkmcnt(0)
v_mfma_f32_32x32x16_bf16 v[224:239], v[156:159], v[108:111], v[224:239]
s_barrier
s_add_u32 s50, s47, 98304
s_lshl_b32 s51, s45, 8
s_add_u32 s51, s51, 2097152
s_mov_b32 m0, s50
s_nop 0
buffer_load_dwordx4 v202, s[28:31], s51 offen lds
s_add_u32 s50, s47, 106496
s_lshl_b32 s51, s45, 8
s_add_u32 s51, s51, 2359296
s_mov_b32 m0, s50
s_nop 0
buffer_load_dwordx4 v202, s[28:31], s51 offen lds
s_add_u32 s50, s47, 114688
s_lshl_b32 s51, s45, 8
s_add_u32 s51, s51, 2621440
s_mov_b32 m0, s50
s_nop 0
buffer_load_dwordx4 v202, s[28:31], s51 offen lds
s_add_u32 s50, s47, 122880
s_lshl_b32 s51, s45, 8
s_add_u32 s51, s51, 2883584
s_mov_b32 m0, s50
s_nop 0
buffer_load_dwordx4 v202, s[28:31], s51 offen lds
s_add_u32 s50, s47, 131072
s_lshl_b32 s51, s45, 8
s_add_u32 s51, s51, 3145728
s_mov_b32 m0, s50
s_nop 0
buffer_load_dwordx4 v202, s[28:31], s51 offen lds
s_add_u32 s50, s47, 139264
s_lshl_b32 s51, s45, 8
s_add_u32 s51, s51, 3407872
s_mov_b32 m0, s50
s_nop 0
buffer_load_dwordx4 v202, s[28:31], s51 offen lds
s_add_u32 s50, s47, 147456
s_lshl_b32 s51, s45, 8
s_add_u32 s51, s51, 3670016
s_mov_b32 m0, s50
s_nop 0
buffer_load_dwordx4 v202, s[28:31], s51 offen lds
s_add_u32 s50, s47, 155648
s_lshl_b32 s51, s45, 8
s_add_u32 s51, s51, 3932160
s_mov_b32 m0, s50
s_nop 0
buffer_load_dwordx4 v202, s[28:31], s51 offen lds
buffer_load_dwordx4 v[48:51], v203, s[16:19], 0 offen offset:512
buffer_load_dwordx4 v[52:55], v203, s[16:19], 0 offen offset:544
buffer_load_dwordx4 v[56:59], v203, s[16:19], 0 offen offset:576
buffer_load_dwordx4 v[60:63], v203, s[16:19], 0 offen offset:608
buffer_load_dwordx4 v[64:67], v203, s[16:19], 0 offen offset:640
buffer_load_dwordx4 v[68:71], v203, s[16:19], 0 offen offset:672
buffer_load_dwordx4 v[72:75], v203, s[16:19], 0 offen offset:704
buffer_load_dwordx4 v[76:79], v203, s[16:19], 0 offen offset:736
buffer_load_dwordx4 v[80:83], v203, s[16:19], 0 offen offset:768
buffer_load_dwordx4 v[84:87], v203, s[16:19], 0 offen offset:800
buffer_load_dwordx4 v[88:91], v203, s[16:19], 0 offen offset:832
buffer_load_dwordx4 v[92:95], v203, s[16:19], 0 offen offset:864
buffer_load_dwordx4 v[96:99], v203, s[16:19], 0 offen offset:896
buffer_load_dwordx4 v[100:103], v203, s[16:19], 0 offen offset:928
buffer_load_dwordx4 v[104:107], v203, s[16:19], 0 offen offset:960
buffer_load_dwordx4 v[108:111], v203, s[16:19], 0 offen offset:992
s_waitcnt vmcnt(0)
s_barrier
ds_read_b64_tr_b16 v[128:129], v204 offset:0
ds_read_b64_tr_b16 v[130:131], v204 offset:1024
ds_read_b64_tr_b16 v[132:133], v205 offset:0
ds_read_b64_tr_b16 v[134:135], v205 offset:1024
ds_read_b64_tr_b16 v[136:137], v204 offset:4096
ds_read_b64_tr_b16 v[138:139], v204 offset:5120
ds_read_b64_tr_b16 v[140:141], v205 offset:4096
ds_read_b64_tr_b16 v[142:143], v205 offset:5120
ds_read_b64_tr_b16 v[144:145], v204 offset:8192
ds_read_b64_tr_b16 v[146:147], v204 offset:9216
s_waitcnt lgkmcnt(8)
v_mfma_f32_32x32x16_bf16 v[208:223], v[128:131], v[48:51], v[208:223]
ds_read_b64_tr_b16 v[148:149], v205 offset:8192
ds_read_b64_tr_b16 v[150:151], v205 offset:9216
s_waitcnt lgkmcnt(8)
v_mfma_f32_32x32x16_bf16 v[224:239], v[132:135], v[48:51], v[224:239]
ds_read_b64_tr_b16 v[152:153], v204 offset:12288
ds_read_b64_tr_b16 v[154:155], v204 offset:13312
s_waitcnt lgkmcnt(8)
v_mfma_f32_32x32x16_bf16 v[208:223], v[136:139], v[52:55], v[208:223]
ds_read_b64_tr_b16 v[156:157], v205 offset:12288
ds_read_b64_tr_b16 v[158:159], v205 offset:13312
s_waitcnt lgkmcnt(8)
v_mfma_f32_32x32x16_bf16 v[224:239], v[140:143], v[52:55], v[224:239]
ds_read_b64_tr_b16 v[128:129], v204 offset:16384
ds_read_b64_tr_b16 v[130:131], v204 offset:17408
s_waitcnt lgkmcnt(8)
v_mfma_f32_32x32x16_bf16 v[208:223], v[144:147], v[56:59], v[208:223]
ds_read_b64_tr_b16 v[132:133], v205 offset:16384
ds_read_b64_tr_b16 v[134:135], v205 offset:17408
s_waitcnt lgkmcnt(8)
v_mfma_f32_32x32x16_bf16 v[224:239], v[148:151], v[56:59], v[224:239]
ds_read_b64_tr_b16 v[136:137], v204 offset:20480
ds_read_b64_tr_b16 v[138:139], v204 offset:21504
s_waitcnt lgkmcnt(8)
v_mfma_f32_32x32x16_bf16 v[208:223], v[152:155], v[60:63], v[208:223]
ds_read_b64_tr_b16 v[140:141], v205 offset:20480
ds_read_b64_tr_b16 v[142:143], v205 offset:21504
s_waitcnt lgkmcnt(8)
v_mfma_f32_32x32x16_bf16 v[224:239], v[156:159], v[60:63], v[224:239]
ds_read_b64_tr_b16 v[144:145], v204 offset:24576
ds_read_b64_tr_b16 v[146:147], v204 offset:25600
s_waitcnt lgkmcnt(8)
v_mfma_f32_32x32x16_bf16 v[208:223], v[128:131], v[64:67], v[208:223]
ds_read_b64_tr_b16 v[148:149], v205 offset:24576
ds_read_b64_tr_b16 v[150:151], v205 offset:25600
s_waitcnt lgkmcnt(8)
v_mfma_f32_32x32x16_bf16 v[224:239], v[132:135], v[64:67], v[224:239]
ds_read_b64_tr_b16 v[152:153], v204 offset:28672
ds_read_b64_tr_b16 v[154:155], v204 offset:29696
s_waitcnt lgkmcnt(8)
v_mfma_f32_32x32x16_bf16 v[208:223], v[136:139], v[68:71], v[208:223]
ds_read_b64_tr_b16 v[156:157], v205 offset:28672
ds_read_b64_tr_b16 v[158:159], v205 offset:29696
s_waitcnt lgkmcnt(8)
v_mfma_f32_32x32x16_bf16 v[224:239], v[140:143], v[68:71], v[224:239]
ds_read_b64_tr_b16 v[128:129], v204 offset:32768
ds_read_b64_tr_b16 v[130:131], v204 offset:33792
s_waitcnt lgkmcnt(8)
v_mfma_f32_32x32x16_bf16 v[208:223], v[144:147], v[72:75], v[208:223]
ds_read_b64_tr_b16 v[132:133], v205 offset:32768
ds_read_b64_tr_b16 v[134:135], v205 offset:33792
s_waitcnt lgkmcnt(8)
v_mfma_f32_32x32x16_bf16 v[224:239], v[148:151], v[72:75], v[224:239]
ds_read_b64_tr_b16 v[136:137], v204 offset:36864
ds_read_b64_tr_b16 v[138:139], v204 offset:37888
s_waitcnt lgkmcnt(8)
v_mfma_f32_32x32x16_bf16 v[208:223], v[152:155], v[76:79], v[208:223]
ds_read_b64_tr_b16 v[140:141], v205 offset:36864
ds_read_b64_tr_b16 v[142:143], v205 offset:37888
s_waitcnt lgkmcnt(8)
v_mfma_f32_32x32x16_bf16 v[224:239], v[156:159], v[76:79], v[224:239]
ds_read_b64_tr_b16 v[144:145], v204 offset:40960
ds_read_b64_tr_b16 v[146:147], v204 offset:41984
s_waitcnt lgkmcnt(8)
v_mfma_f32_32x32x16_bf16 v[208:223], v[128:131], v[80:83], v[208:223]
ds_read_b64_tr_b16 v[148:149], v205 offset:40960
ds_read_b64_tr_b16 v[150:151], v205 offset:41984
s_waitcnt lgkmcnt(8)
v_mfma_f32_32x32x16_bf16 v[224:239], v[132:135], v[80:83], v[224:239]
ds_read_b64_tr_b16 v[152:153], v204 offset:45056
ds_read_b64_tr_b16 v[154:155], v204 offset:46080
s_waitcnt lgkmcnt(8)
v_mfma_f32_32x32x16_bf16 v[208:223], v[136:139], v[84:87], v[208:223]
ds_read_b64_tr_b16 v[156:157], v205 offset:45056
ds_read_b64_tr_b16 v[158:159], v205 offset:46080
s_waitcnt lgkmcnt(8)
v_mfma_f32_32x32x16_bf16 v[224:239], v[140:143], v[84:87], v[224:239]
ds_read_b64_tr_b16 v[128:129], v204 offset:49152
ds_read_b64_tr_b16 v[130:131], v204 offset:50176
s_waitcnt lgkmcnt(8)
v_mfma_f32_32x32x16_bf16 v[208:223], v[144:147], v[88:91], v[208:223]
ds_read_b64_tr_b16 v[132:133], v205 offset:49152
ds_read_b64_tr_b16 v[134:135], v205 offset:50176
s_waitcnt lgkmcnt(8)
v_mfma_f32_32x32x16_bf16 v[224:239], v[148:151], v[88:91], v[224:239]
ds_read_b64_tr_b16 v[136:137], v204 offset:53248
ds_read_b64_tr_b16 v[138:139], v204 offset:54272
s_waitcnt lgkmcnt(8)
v_mfma_f32_32x32x16_bf16 v[208:223], v[152:155], v[92:95], v[208:223]
ds_read_b64_tr_b16 v[140:141], v205 offset:53248
ds_read_b64_tr_b16 v[142:143], v205 offset:54272
s_waitcnt lgkmcnt(8)
v_mfma_f32_32x32x16_bf16 v[224:239], v[156:159], v[92:95], v[224:239]
ds_read_b64_tr_b16 v[144:145], v204 offset:57344
ds_read_b64_tr_b16 v[146:147], v204 offset:58368
s_waitcnt lgkmcnt(8)
v_mfma_f32_32x32x16_bf16 v[208:223], v[128:131], v[96:99], v[208:223]
ds_read_b64_tr_b16 v[148:149], v205 offset:57344
ds_read_b64_tr_b16 v[150:151], v205 offset:58368
s_waitcnt lgkmcnt(8)
v_mfma_f32_32x32x16_bf16 v[224:239], v[132:135], v[96:99], v[224:239]
ds_read_b64_tr_b16 v[152:153], v204 offset:61440
ds_read_b64_tr_b16 v[154:155], v204 offset:62464
s_waitcnt lgkmcnt(8)
v_mfma_f32_32x32x16_bf16 v[208:223], v[136:139], v[100:103], v[208:223]
ds_read_b64_tr_b16 v[156:157], v205 offset:61440
ds_read_b64_tr_b16 v[158:159], v205 offset:62464
s_waitcnt lgkmcnt(8)
v_mfma_f32_32x32x16_bf16 v[224:239], v[140:143], v[100:103], v[224:239]
s_waitcnt lgkmcnt(6)
v_mfma_f32_32x32x16_bf16 v[208:223], v[144:147], v[104:107], v[208:223]
s_waitcnt lgkmcnt(4)
v_mfma_f32_32x32x16_bf16 v[224:239], v[148:151], v[104:107], v[224:239]
s_waitcnt lgkmcnt(2)
v_mfma_f32_32x32x16_bf16 v[208:223], v[152:155], v[108:111], v[208:223]
s_waitcnt lgkmcnt(0)
v_mfma_f32_32x32x16_bf16 v[224:239], v[156:159], v[108:111], v[224:239]
s_nop 15
s_barrier
v_cvt_pk_bf16_f32 v128, v208, v209
v_cvt_pk_bf16_f32 v129, v210, v211
v_cvt_pk_bf16_f32 v130, v212, v213
v_cvt_pk_bf16_f32 v131, v214, v215
v_cvt_pk_bf16_f32 v132, v216, v217
v_cvt_pk_bf16_f32 v133, v218, v219
v_cvt_pk_bf16_f32 v134, v220, v221
v_cvt_pk_bf16_f32 v135, v222, v223
v_cvt_pk_bf16_f32 v136, v224, v225
v_cvt_pk_bf16_f32 v137, v226, v227
v_cvt_pk_bf16_f32 v138, v228, v229
v_cvt_pk_bf16_f32 v139, v230, v231
v_cvt_pk_bf16_f32 v140, v232, v233
v_cvt_pk_bf16_f32 v141, v234, v235
v_cvt_pk_bf16_f32 v142, v236, v237
v_cvt_pk_bf16_f32 v143, v238, v239
v_lshlrev_b32 v10, 6, v0
v_add_u32 v10, 0x18000, v10
v_xor_b32 v11, 0x4000, v10
ds_write_b128 v10, v[128:131] offset:0
ds_write_b128 v10, v[132:135] offset:16
ds_write_b128 v10, v[136:139] offset:32
ds_write_b128 v10, v[140:143] offset:48
s_waitcnt lgkmcnt(0)
s_barrier
ds_read_b128 v[160:163], v11 offset:0
ds_read_b128 v[164:167], v11 offset:16
ds_read_b128 v[168:171], v11 offset:32
ds_read_b128 v[172:175], v11 offset:48
s_waitcnt lgkmcnt(0)
s_cmp_eq_u32 s41, 0
s_cbranch_scc0 A_g1
v_mov_b32 v16, v128
v_mov_b32 v32, v160
v_mov_b32 v17, v129
v_mov_b32 v33, v161
v_mov_b32 v18, v130
v_mov_b32 v34, v162
v_mov_b32 v19, v131
v_mov_b32 v35, v163
v_mov_b32 v20, v132
v_mov_b32 v36, v164
v_mov_b32 v21, v133
v_mov_b32 v37, v165
v_mov_b32 v22, v134
v_mov_b32 v38, v166
v_mov_b32 v23, v135
v_mov_b32 v39, v167
v_mov_b32 v24, v136
v_mov_b32 v40, v168
v_mov_b32 v25, v137
v_mov_b32 v41, v169
v_mov_b32 v26, v138
v_mov_b32 v42, v170
v_mov_b32 v27, v139
v_mov_b32 v43, v171
v_mov_b32 v28, v140
v_mov_b32 v44, v172
v_mov_b32 v29, v141
v_mov_b32 v45, v173
v_mov_b32 v30, v142
v_mov_b32 v46, v174
v_mov_b32 v31, v143
v_mov_b32 v47, v175
s_branch A_q
A_g1:
v_mov_b32 v32, v128
v_mov_b32 v16, v160
v_mov_b32 v33, v129
v_mov_b32 v17, v161
v_mov_b32 v34, v130
v_mov_b32 v18, v162
v_mov_b32 v35, v131
v_mov_b32 v19, v163
v_mov_b32 v36, v132
v_mov_b32 v20, v164
v_mov_b32 v37, v133
v_mov_b32 v21, v165
v_mov_b32 v38, v134
v_mov_b32 v22, v166
v_mov_b32 v39, v135
v_mov_b32 v23, v167
v_mov_b32 v40, v136
v_mov_b32 v24, v168
v_mov_b32 v41, v137
v_mov_b32 v25, v169
v_mov_b32 v42, v138
v_mov_b32 v26, v170
v_mov_b32 v43, v139
v_mov_b32 v27, v171
v_mov_b32 v44, v140
v_mov_b32 v28, v172
v_mov_b32 v45, v141
v_mov_b32 v29, v173
v_mov_b32 v46, v142
v_mov_b32 v30, v174
v_mov_b32 v47, v143
v_mov_b32 v31, v175
A_q:
s_barrier
v_mov_b32 v48, 0
v_mov_b32 v49, 0
v_mov_b32 v50, 0
v_mov_b32 v51, 0
v_mov_b32 v52, 0
v_mov_b32 v53, 0
v_mov_b32 v54, 0
v_mov_b32 v55, 0
v_mov_b32 v56, 0
v_mov_b32 v57, 0
v_mov_b32 v58, 0
v_mov_b32 v59, 0
v_mov_b32 v60, 0
v_mov_b32 v61, 0
v_mov_b32 v62, 0
v_mov_b32 v63, 0
v_mov_b32 v64, 0
v_mov_b32 v65, 0
v_mov_b32 v66, 0
v_mov_b32 v67, 0
v_mov_b32 v68, 0
v_mov_b32 v69, 0
v_mov_b32 v70, 0
v_mov_b32 v71, 0
v_mov_b32 v72, 0
v_mov_b32 v73, 0
v_mov_b32 v74, 0
v_mov_b32 v75, 0
v_mov_b32 v76, 0
v_mov_b32 v77, 0
v_mov_b32 v78, 0
v_mov_b32 v79, 0
v_mov_b32 v80, 0
v_mov_b32 v81, 0
v_mov_b32 v82, 0
v_mov_b32 v83, 0
v_mov_b32 v84, 0
v_mov_b32 v85, 0
v_mov_b32 v86, 0
v_mov_b32 v87, 0
v_mov_b32 v88, 0
v_mov_b32 v89, 0
v_mov_b32 v90, 0
v_mov_b32 v91, 0
v_mov_b32 v92, 0
v_mov_b32 v93, 0
v_mov_b32 v94, 0
v_mov_b32 v95, 0
v_mov_b32 v96, 0
v_mov_b32 v97, 0
v_mov_b32 v98, 0
v_mov_b32 v99, 0
v_mov_b32 v100, 0
v_mov_b32 v101, 0
v_mov_b32 v102, 0
v_mov_b32 v103, 0
v_mov_b32 v104, 0
v_mov_b32 v105, 0
v_mov_b32 v106, 0
v_mov_b32 v107, 0
v_mov_b32 v108, 0
v_mov_b32 v109, 0
v_mov_b32 v110, 0
v_mov_b32 v111, 0
v_mov_b32 v212, 0xff800000
v_mov_b32 v213, 0
s_mov_b32 s60, 0x3e0293ee
s_mov_b32 s61, 0
A_loop:
s_cmp_ge_u32 s61, 29
s_cbranch_scc1 A_w0
s_waitcnt vmcnt(8)
s_branch A_w1
A_w0:
s_waitcnt vmcnt(0)
A_w1:
s_barrier
s_cmp_ge_u32 s61, 29
s_cbranch_scc1 A_nodma
s_add_u32 s52, s61, 3
s_and_b32 s53, s52, 3
s_lshl_b32 s53, s53, 15
s_add_u32 s52, s52, s62
s_and_b32 s52, s52, 31
s_lshl_b32 s52, s52, 14
s_add_u32 s52, s52, s43
s_add_u32 s50, s53, s47
s_add_u32 s50, s50, 0
s_add_u32 s51, s52, 0
s_mov_b32 m0, s50
s_nop 0
buffer_load_dwordx4 v200, s[20:23], s51 offen nt lds
s_add_u32 s50, s53, s47
s_add_u32 s50, s50, 8192
s_add_u32 s51, s52, 8192
s_mov_b32 m0, s50
s_nop 0
buffer_load_dwordx4 v200, s[20:23], s51 offen nt lds
s_add_u32 s50, s53, s47
s_add_u32 s50, s50, 16384
s_add_u32 s51, s52, 0
s_mov_b32 m0, s50
s_nop 0
buffer_load_dwordx4 v201, s[24:27], s51 offen nt lds
s_add_u32 s50, s53, s47
s_add_u32 s50, s50, 24576
s_add_u32 s51, s52, 8192
s_mov_b32 m0, s50
s_nop 0
buffer_load_dwordx4 v201, s[24:27], s51 offen nt lds
A_nodma:
s_and_b32 s53, s61, 3
s_lshl_b32 s53, s53, 15
v_add_u32 v10, s53, v207
v_add_u32 v11, s53, v206
v_xor_b32 v12, 0, v10
ds_read_b128 v[128:131], v12
v_xor_b32 v12, 32, v10
ds_read_b128 v[132:135], v12
v_xor_b32 v12, 64, v10
ds_read_b128 v[136:139], v12
v_xor_b32 v12, 96, v10
ds_read_b128 v[140:143], v12
v_xor_b32 v12, 128, v10
ds_read_b128 v[144:147], v12
v_xor_b32 v12, 160, v10
ds_read_b128 v[148:151], v12
v_xor_b32 v12, 192, v10
ds_read_b128 v[152:155], v12
v_xor_b32 v12, 224, v10
ds_read_b128 v[156:159], v12
v_xor_b32 v216, 0, v11
v_xor_b32 v217, 64, v11
v_xor_b32 v218, 128, v11
v_xor_b32 v219, 192, v11
s_waitcnt lgkmcnt(7)
v_mfma_f32_32x32x16_bf16 v[112:127], v[128:131], v[16:19], 0
s_waitcnt lgkmcnt(6)
v_mfma_f32_32x32x16_bf16 v[112:127], v[132:135], v[20:23], v[112:127]
s_waitcnt lgkmcnt(5)
v_mfma_f32_32x32x16_bf16 v[112:127], v[136:139], v[24:27], v[112:127]
s_waitcnt lgkmcnt(4)
v_mfma_f32_32x32x16_bf16 v[112:127], v[140:143], v[28:31], v[112:127]
s_waitcnt lgkmcnt(3)
v_mfma_f32_32x32x16_bf16 v[112:127], v[144:147], v[32:35], v[112:127]
s_waitcnt lgkmcnt(2)
v_mfma_f32_32x32x16_bf16 v[112:127], v[148:151], v[36:39], v[112:127]
s_waitcnt lgkmcnt(1)
v_mfma_f32_32x32x16_bf16 v[112:127], v[152:155], v[40:43], v[112:127]
s_waitcnt lgkmcnt(0)
v_mfma_f32_32x32x16_bf16 v[112:127], v[156:159], v[44:47], v[112:127]
ds_read_b64_tr_b16 v[160:161], v216 offset:0
ds_read_b64_tr_b16 v[162:163], v216 offset:2048
ds_read_b64_tr_b16 v[164:165], v216 offset:4096
ds_read_b64_tr_b16 v[166:167], v216 offset:6144
ds_read_b64_tr_b16 v[168:169], v217 offset:0
ds_read_b64_tr_b16 v[170:171], v217 offset:2048
ds_read_b64_tr_b16 v[172:173], v217 offset:4096
ds_read_b64_tr_b16 v[174:175], v217 offset:6144
ds_read_b64_tr_b16 v[176:177], v218 offset:0
ds_read_b64_tr_b16 v[178:179], v218 offset:2048
ds_read_b64_tr_b16 v[180:181], v218 offset:4096
ds_read_b64_tr_b16 v[182:183], v218 offset:6144
ds_read_b64_tr_b16 v[184:185], v219 offset:0
ds_read_b64_tr_b16 v[186:187], v219 offset:2048
ds_read_b64_tr_b16 v[188:189], v219 offset:4096
ds_read_b64_tr_b16 v[190:191], v219 offset:6144
s_nop 7
v_max3_f32 v14, v112, v113, v212
v_max3_f32 v14, v114, v115, v14
v_max3_f32 v14, v116, v117, v14
v_max3_f32 v14, v118, v119, v14
v_max3_f32 v14, v120, v121, v14
v_max3_f32 v14, v122, v123, v14
v_max3_f32 v14, v124, v125, v14
v_max3_f32 v14, v126, v127, v14
v_mov_b32 v15, v14
s_nop 1
v_permlane32_swap_b32 v14, v15
s_nop 1
v_max_f32 v14, v14, v15
v_sub_f32 v15, v212, v14
v_mul_f32 v15, s60, v15
v_exp_f32 v15, v15
v_mov_b32 v212, v14
v_mul_f32 v14, s60, v14
v_fma_f32 v112, v112, s60, -v14
v_fma_f32 v113, v113, s60, -v14
v_fma_f32 v114, v114, s60, -v14
v_fma_f32 v115, v115, s60, -v14
v_fma_f32 v116, v116, s60, -v14
v_fma_f32 v117, v117, s60, -v14
v_fma_f32 v118, v118, s60, -v14
v_fma_f32 v119, v119, s60, -v14
v_fma_f32 v120, v120, s60, -v14
v_fma_f32 v121, v121, s60, -v14
v_fma_f32 v122, v122, s60, -v14
v_fma_f32 v123, v123, s60, -v14
v_fma_f32 v124, v124, s60, -v14
v_fma_f32 v125, v125, s60, -v14
v_fma_f32 v126, v126, s60, -v14
v_fma_f32 v127, v127, s60, -v14
v_exp_f32 v112, v112
v_exp_f32 v113, v113
v_exp_f32 v114, v114
v_exp_f32 v115, v115
v_exp_f32 v116, v116
v_exp_f32 v117, v117
v_exp_f32 v118, v118
v_exp_f32 v119, v119
v_exp_f32 v120, v120
v_exp_f32 v121, v121
v_exp_f32 v122, v122
v_exp_f32 v123, v123
v_exp_f32 v124, v124
v_exp_f32 v125, v125
v_exp_f32 v126, v126
v_exp_f32 v127, v127
v_mul_f32 v213, v213, v15
v_add_f32 v213, v213, v112
v_add_f32 v213, v213, v113
v_add_f32 v213, v213, v114
v_add_f32 v213, v213, v115
v_add_f32 v213, v213, v116
v_add_f32 v213, v213, v117
v_add_f32 v213, v213, v118
v_add_f32 v213, v213, v119
v_add_f32 v213, v213, v120
v_add_f32 v213, v213, v121
v_add_f32 v213, v213, v122
v_add_f32 v213, v213, v123
v_add_f32 v213, v213, v124
v_add_f32 v213, v213, v125
v_add_f32 v213, v213, v126
v_add_f32 v213, v213, v127
v_cvt_pk_bf16_f32 v192, v112, v113
v_cvt_pk_bf16_f32 v193, v114, v115
v_cvt_pk_bf16_f32 v194, v116, v117
v_cvt_pk_bf16_f32 v195, v118, v119
v_cvt_pk_bf16_f32 v196, v120, v121
v_cvt_pk_bf16_f32 v197, v122, v123
v_cvt_pk_bf16_f32 v198, v124, v125
v_cvt_pk_bf16_f32 v199, v126, v127
v_cmp_neq_f32 vcc, 1.0, v15
s_nop 1
s_cbranch_vccz A_nors
v_mul_f32 v48, v48, v15
v_mul_f32 v49, v49, v15
v_mul_f32 v50, v50, v15
v_mul_f32 v51, v51, v15
v_mul_f32 v52, v52, v15
v_mul_f32 v53, v53, v15
v_mul_f32 v54, v54, v15
v_mul_f32 v55, v55, v15
v_mul_f32 v56, v56, v15
v_mul_f32 v57, v57, v15
v_mul_f32 v58, v58, v15
v_mul_f32 v59, v59, v15
v_mul_f32 v60, v60, v15
v_mul_f32 v61, v61, v15
v_mul_f32 v62, v62, v15
v_mul_f32 v63, v63, v15
v_mul_f32 v64, v64, v15
v_mul_f32 v65, v65, v15
v_mul_f32 v66, v66, v15
v_mul_f32 v67, v67, v15
v_mul_f32 v68, v68, v15
v_mul_f32 v69, v69, v15
v_mul_f32 v70, v70, v15
v_mul_f32 v71, v71, v15
v_mul_f32 v72, v72, v15
v_mul_f32 v73, v73, v15
v_mul_f32 v74, v74, v15
v_mul_f32 v75, v75, v15
v_mul_f32 v76, v76, v15
v_mul_f32 v77, v77, v15
v_mul_f32 v78, v78, v15
v_mul_f32 v79, v79, v15
v_mul_f32 v80, v80, v15
v_mul_f32 v81, v81, v15
v_mul_f32 v82, v82, v15
v_mul_f32 v83, v83, v15
v_mul_f32 v84, v84, v15
v_mul_f32 v85, v85, v15
v_mul_f32 v86, v86, v15
v_mul_f32 v87, v87, v15
v_mul_f32 v88, v88, v15
v_mul_f32 v89, v89, v15
v_mul_f32 v90, v90, v15
v_mul_f32 v91, v91, v15
v_mul_f32 v92, v92, v15
v_mul_f32 v93, v93, v15
v_mul_f32 v94, v94, v15
v_mul_f32 v95, v95, v15
v_mul_f32 v96, v96, v15
v_mul_f32 v97, v97, v15
v_mul_f32 v98, v98, v15
v_mul_f32 v99, v99, v15
v_mul_f32 v100, v100, v15
v_mul_f32 v101, v101, v15
v_mul_f32 v102, v102, v15
v_mul_f32 v103, v103, v15
v_mul_f32 v104, v104, v15
v_mul_f32 v105, v105, v15
v_mul_f32 v106, v106, v15
v_mul_f32 v107, v107, v15
v_mul_f32 v108, v108, v15
v_mul_f32 v109, v109, v15
v_mul_f32 v110, v110, v15
v_mul_f32 v111, v111, v15
A_nors:
s_waitcnt lgkmcnt(0)
s_nop 1
v_mfma_f32_32x32x16_bf16 v[48:63], v[160:163], v[192:195], v[48:63]
v_mfma_f32_32x32x16_bf16 v[48:63], v[164:167], v[196:199], v[48:63]
v_mfma_f32_32x32x16_bf16 v[64:79], v[168:171], v[192:195], v[64:79]
v_mfma_f32_32x32x16_bf16 v[64:79], v[172:175], v[196:199], v[64:79]
v_mfma_f32_32x32x16_bf16 v[80:95], v[176:179], v[192:195], v[80:95]
v_mfma_f32_32x32x16_bf16 v[80:95], v[180:183], v[196:199], v[80:95]
v_mfma_f32_32x32x16_bf16 v[96:111], v[184:187], v[192:195], v[96:111]
v_mfma_f32_32x32x16_bf16 v[96:111], v[188:191], v[196:199], v[96:111]
A_next:
s_add_u32 s61, s61, 1
s_cmp_lt_u32 s61, 32
s_cbranch_scc1 A_loop
s_nop 15
v_mov_b32 v15, v213
s_nop 1
v_permlane32_swap_b32 v213, v15
s_nop 1
v_add_f32 v213, v213, v15
s_barrier
v_lshlrev_b32 v10, 4, v1
s_lshl_b32 s50, s40, 13
v_add_u32 v10, s50, v10
v_xor_b32 v11, 0x8000, v10
v_lshlrev_b32 v12, 3, v0
v_add_u32 v12, 0x10000, v12
v_xor_b32 v13, 0x800, v12
ds_write_b64 v12, v[212:213]
s_cmp_eq_u32 s41, 0
s_cbranch_scc0 A_e1
ds_write_b128 v10, v[80:83] offset:0
ds_write_b128 v10, v[84:87] offset:1024
ds_write_b128 v10, v[88:91] offset:2048
ds_write_b128 v10, v[92:95] offset:3072
ds_write_b128 v10, v[96:99] offset:4096
ds_write_b128 v10, v[100:103] offset:5120
ds_write_b128 v10, v[104:107] offset:6144
ds_write_b128 v10, v[108:111] offset:7168
s_branch A_e2
A_e1:
ds_write_b128 v10, v[48:51] offset:0
ds_write_b128 v10, v[52:55] offset:1024
ds_write_b128 v10, v[56:59] offset:2048
ds_write_b128 v10, v[60:63] offset:3072
ds_write_b128 v10, v[64:67] offset:4096
ds_write_b128 v10, v[68:71] offset:5120
ds_write_b128 v10, v[72:75] offset:6144
ds_write_b128 v10, v[76:79] offset:7168
v_mov_b32 v48, v80
v_mov_b32 v49, v81
v_mov_b32 v50, v82
v_mov_b32 v51, v83
v_mov_b32 v52, v84
v_mov_b32 v53, v85
v_mov_b32 v54, v86
v_mov_b32 v55, v87
v_mov_b32 v56, v88
v_mov_b32 v57, v89
v_mov_b32 v58, v90
v_mov_b32 v59, v91
v_mov_b32 v60, v92
v_mov_b32 v61, v93
v_mov_b32 v62, v94
v_mov_b32 v63, v95
v_mov_b32 v64, v96
v_mov_b32 v65, v97
v_mov_b32 v66, v98
v_mov_b32 v67, v99
v_mov_b32 v68, v100
v_mov_b32 v69, v101
v_mov_b32 v70, v102
v_mov_b32 v71, v103
v_mov_b32 v72, v104
v_mov_b32 v73, v105
v_mov_b32 v74, v106
v_mov_b32 v75, v107
v_mov_b32 v76, v108
v_mov_b32 v77, v109
v_mov_b32 v78, v110
v_mov_b32 v79, v111
A_e2:
s_waitcnt lgkmcnt(0)
s_barrier
ds_read_b64 v[214:215], v13
ds_read_b128 v[128:131], v11 offset:0
ds_read_b128 v[132:135], v11 offset:1024
ds_read_b128 v[136:139], v11 offset:2048
ds_read_b128 v[140:143], v11 offset:3072
ds_read_b128 v[144:147], v11 offset:4096
ds_read_b128 v[148:151], v11 offset:5120
ds_read_b128 v[152:155], v11 offset:6144
ds_read_b128 v[156:159], v11 offset:7168
s_waitcnt lgkmcnt(0)
v_max_f32 v14, v212, v214
v_sub_f32 v212, v212, v14
v_sub_f32 v214, v214, v14
v_mul_f32 v212, s60, v212
v_mul_f32 v214, s60, v214
v_exp_f32 v212, v212
v_exp_f32 v214, v214
s_nop 0
v_mul_f32 v14, v212, v213
v_fma_f32 v14, v214, v215, v14
v_rcp_f32 v14, v14
s_nop 0
v_mul_f32 v212, v212, v14
v_mul_f32 v214, v214, v14
v_mul_f32 v48, v48, v212
v_fma_f32 v48, v128, v214, v48
v_mul_f32 v49, v49, v212
v_fma_f32 v49, v129, v214, v49
v_mul_f32 v50, v50, v212
v_fma_f32 v50, v130, v214, v50
v_mul_f32 v51, v51, v212
v_fma_f32 v51, v131, v214, v51
v_mul_f32 v52, v52, v212
v_fma_f32 v52, v132, v214, v52
v_mul_f32 v53, v53, v212
v_fma_f32 v53, v133, v214, v53
v_mul_f32 v54, v54, v212
v_fma_f32 v54, v134, v214, v54
v_mul_f32 v55, v55, v212
v_fma_f32 v55, v135, v214, v55
v_mul_f32 v56, v56, v212
v_fma_f32 v56, v136, v214, v56
v_mul_f32 v57, v57, v212
v_fma_f32 v57, v137, v214, v57
v_mul_f32 v58, v58, v212
v_fma_f32 v58, v138, v214, v58
v_mul_f32 v59, v59, v212
v_fma_f32 v59, v139, v214, v59
v_mul_f32 v60, v60, v212
v_fma_f32 v60, v140, v214, v60
v_mul_f32 v61, v61, v212
v_fma_f32 v61, v141, v214, v61
v_mul_f32 v62, v62, v212
v_fma_f32 v62, v142, v214, v62
v_mul_f32 v63, v63, v212
v_fma_f32 v63, v143, v214, v63
v_mul_f32 v64, v64, v212
v_fma_f32 v64, v144, v214, v64
v_mul_f32 v65, v65, v212
v_fma_f32 v65, v145, v214, v65
v_mul_f32 v66, v66, v212
v_fma_f32 v66, v146, v214, v66
v_mul_f32 v67, v67, v212
v_fma_f32 v67, v147, v214, v67
v_mul_f32 v68, v68, v212
v_fma_f32 v68, v148, v214, v68
v_mul_f32 v69, v69, v212
v_fma_f32 v69, v149, v214, v69
v_mul_f32 v70, v70, v212
v_fma_f32 v70, v150, v214, v70
v_mul_f32 v71, v71, v212
v_fma_f32 v71, v151, v214, v71
v_mul_f32 v72, v72, v212
v_fma_f32 v72, v152, v214, v72
v_mul_f32 v73, v73, v212
v_fma_f32 v73, v153, v214, v73
v_mul_f32 v74, v74, v212
v_fma_f32 v74, v154, v214, v74
v_mul_f32 v75, v75, v212
v_fma_f32 v75, v155, v214, v75
v_mul_f32 v76, v76, v212
v_fma_f32 v76, v156, v214, v76
v_mul_f32 v77, v77, v212
v_fma_f32 v77, v157, v214, v77
v_mul_f32 v78, v78, v212
v_fma_f32 v78, v158, v214, v78
v_mul_f32 v79, v79, v212
v_fma_f32 v79, v159, v214, v79
v_cvt_pk_bf16_f32 v112, v48, v49
v_cvt_pk_bf16_f32 v113, v50, v51
v_cvt_pk_bf16_f32 v114, v52, v53
v_cvt_pk_bf16_f32 v115, v54, v55
v_cvt_pk_bf16_f32 v116, v56, v57
v_cvt_pk_bf16_f32 v117, v58, v59
v_cvt_pk_bf16_f32 v118, v60, v61
v_cvt_pk_bf16_f32 v119, v62, v63
v_cvt_pk_bf16_f32 v120, v64, v65
v_cvt_pk_bf16_f32 v121, v66, v67
v_cvt_pk_bf16_f32 v122, v68, v69
v_cvt_pk_bf16_f32 v123, v70, v71
v_cvt_pk_bf16_f32 v124, v72, v73
v_cvt_pk_bf16_f32 v125, v74, v75
v_cvt_pk_bf16_f32 v126, v76, v77
v_cvt_pk_bf16_f32 v127, v78, v79
s_lshl_b32 s54, s44, 2
s_add_u32 s54, s54, s42
s_lshl_b32 s54, s54, 18
s_lshl_b32 s55, s45, 13
s_add_u32 s54, s54, s55
s_lshl_b32 s55, s41, 12
s_add_u32 s54, s54, s55
v_lshlrev_b32 v10, 4, v8
v_lshl_add_u32 v10, v9, 3, v10
buffer_store_dwordx2 v[112:113], v10, s[32:35], s54 offen offset:0
buffer_store_dwordx2 v[114:115], v10, s[32:35], s54 offen offset:512
buffer_store_dwordx2 v[116:117], v10, s[32:35], s54 offen offset:1024
buffer_store_dwordx2 v[118:119], v10, s[32:35], s54 offen offset:1536
buffer_store_dwordx2 v[120:121], v10, s[32:35], s54 offen offset:2048
buffer_store_dwordx2 v[122:123], v10, s[32:35], s54 offen offset:2560
buffer_store_dwordx2 v[124:125], v10, s[32:35], s54 offen offset:3072
buffer_store_dwordx2 v[126:127], v10, s[32:35], s54 offen offset:3584
A_end:
s_endpgm
.section .rodata,"a"
.p2align 6
.amdhsa_kernel attn_kernel
  .amdhsa_next_free_vgpr 256
  .amdhsa_next_free_sgpr 102
  .amdhsa_accum_offset 256
  .amdhsa_group_segment_fixed_size 0
  .amdhsa_kernarg_size 64
  .amdhsa_user_sgpr_count 2
  .amdhsa_user_sgpr_kernarg_segment_ptr 1
  .amdhsa_system_sgpr_workgroup_id_x 1
.end_amdhsa_kernel
.text

.globl oproj_kernel
.p2align 8
.type oproj_kernel,@function
oproj_kernel:
s_cmp_ge_u32 s2, 256
s_cbranch_scc1 B_end
s_load_dwordx4 s[4:7], s[0:1], 32
s_load_dwordx2 s[12:13], s[0:1], 56
s_waitcnt lgkmcnt(0)
s_mov_b32 s16, s4
s_mov_b32 s17, s5
s_mov_b32 s18, 4194304
s_mov_b32 s19, 0x00020000
s_mov_b32 s20, s6
s_mov_b32 s21, s7
s_mov_b32 s22, 1048576
s_mov_b32 s23, 0x00020000
s_mov_b32 s24, s12
s_mov_b32 s25, s13
s_mov_b32 s26, 8388608
s_mov_b32 s27, 0x00020000
v_and_b32 v1, 63, v0
v_lshrrev_b32 v2, 6, v0
s_nop 0
v_readfirstlane_b32 s40, v2
s_nop 3
s_and_b32 s41, s2, 15
s_lshr_b32 s42, s2, 4
v_lshrrev_b32 v3, 2, v1
v_and_b32 v4, 3, v1
v_lshlrev_b32 v3, 10, v3
v_lshl_add_u32 v200, v4, 4, v3
s_lshl_b32 s43, s40, 20
s_lshl_b32 s44, s41, 6
s_add_u32 s43, s43, s44
s_lshl_b32 s45, s40, 15
v_and_b32 v8, 31, v1
v_lshrrev_b32 v9, 5, v1
s_lshl_b32 s46, s42, 19
s_lshl_b32 s47, s40, 16
s_add_u32 s46, s46, s47
v_lshlrev_b32 v201, 4, v1
v_add_u32 v201, s46, v201
v_add_u32 v202, 0x40000, v201
v_and_b32 v11, 3, v1
v_bfe_u32 v12, v1, 2, 2
v_bfe_u32 v13, v1, 4, 1
v_lshl_add_u32 v12, v9, 3, v12
v_lshlrev_b32 v12, 6, v12
v_lshl_add_u32 v12, v13, 5, v12
v_lshl_add_u32 v12, v11, 3, v12
v_add_u32 v203, s45, v12
v_mov_b32 v160, 0
v_mov_b32 v161, 0
v_mov_b32 v162, 0
v_mov_b32 v163, 0
v_mov_b32 v164, 0
v_mov_b32 v165, 0
v_mov_b32 v166, 0
v_mov_b32 v167, 0
v_mov_b32 v168, 0
v_mov_b32 v169, 0
v_mov_b32 v170, 0
v_mov_b32 v171, 0
v_mov_b32 v172, 0
v_mov_b32 v173, 0
v_mov_b32 v174, 0
v_mov_b32 v175, 0
v_mov_b32 v176, 0
v_mov_b32 v177, 0
v_mov_b32 v178, 0
v_mov_b32 v179, 0
v_mov_b32 v180, 0
v_mov_b32 v181, 0
v_mov_b32 v182, 0
v_mov_b32 v183, 0
v_mov_b32 v184, 0
v_mov_b32 v185, 0
v_mov_b32 v186, 0
v_mov_b32 v187, 0
v_mov_b32 v188, 0
v_mov_b32 v189, 0
v_mov_b32 v190, 0
v_mov_b32 v191, 0
s_add_u32 s50, s45, 0
s_add_u32 s51, s43, 0
s_mov_b32 m0, s50
s_nop 0
buffer_load_dwordx4 v200, s[16:19], s51 offen lds
s_add_u32 s50, s45, 1024
s_add_u32 s51, s43, 16384
s_mov_b32 m0, s50
s_nop 0
buffer_load_dwordx4 v200, s[16:19], s51 offen lds
s_add_u32 s50, s45, 2048
s_add_u32 s51, s43, 32768
s_mov_b32 m0, s50
s_nop 0
buffer_load_dwordx4 v200, s[16:19], s51 offen lds
s_add_u32 s50, s45, 3072
s_add_u32 s51, s43, 49152
s_mov_b32 m0, s50
s_nop 0
buffer_load_dwordx4 v200, s[16:19], s51 offen lds
s_add_u32 s50, s45, 4096
s_add_u32 s51, s43, 65536
s_mov_b32 m0, s50
s_nop 0
buffer_load_dwordx4 v200, s[16:19], s51 offen lds
s_add_u32 s50, s45, 5120
s_add_u32 s51, s43, 81920
s_mov_b32 m0, s50
s_nop 0
buffer_load_dwordx4 v200, s[16:19], s51 offen lds
s_add_u32 s50, s45, 6144
s_add_u32 s51, s43, 98304
s_mov_b32 m0, s50
s_nop 0
buffer_load_dwordx4 v200, s[16:19], s51 offen lds
s_add_u32 s50, s45, 7168
s_add_u32 s51, s43, 114688
s_mov_b32 m0, s50
s_nop 0
buffer_load_dwordx4 v200, s[16:19], s51 offen lds
s_mov_b32 s51, 0
buffer_load_dwordx4 v[16:19], v201, s[24:27], s51 offen
buffer_load_dwordx4 v[20:23], v202, s[24:27], s51 offen
s_mov_b32 s51, 1024
buffer_load_dwordx4 v[24:27], v201, s[24:27], s51 offen
buffer_load_dwordx4 v[28:31], v202, s[24:27], s51 offen
s_mov_b32 s51, 2048
buffer_load_dwordx4 v[32:35], v201, s[24:27], s51 offen
buffer_load_dwordx4 v[36:39], v202, s[24:27], s51 offen
s_mov_b32 s51, 3072
buffer_load_dwordx4 v[40:43], v201, s[24:27], s51 offen
buffer_load_dwordx4 v[44:47], v202, s[24:27], s51 offen
s_mov_b32 s51, 4096
buffer_load_dwordx4 v[48:51], v201, s[24:27], s51 offen
buffer_load_dwordx4 v[52:55], v202, s[24:27], s51 offen
s_mov_b32 s51, 5120
buffer_load_dwordx4 v[56:59], v201, s[24:27], s51 offen
buffer_load_dwordx4 v[60:63], v202, s[24:27], s51 offen
s_mov_b32 s51, 6144
buffer_load_dwordx4 v[64:67], v201, s[24:27], s51 offen
buffer_load_dwordx4 v[68:71], v202, s[24:27], s51 offen
s_mov_b32 s51, 7168
buffer_load_dwordx4 v[72:75], v201, s[24:27], s51 offen
buffer_load_dwordx4 v[76:79], v202, s[24:27], s51 offen
s_add_u32 s50, s45, 8192
s_add_u32 s51, s43, 131072
s_mov_b32 m0, s50
s_nop 0
buffer_load_dwordx4 v200, s[16:19], s51 offen lds
s_add_u32 s50, s45, 9216
s_add_u32 s51, s43, 147456
s_mov_b32 m0, s50
s_nop 0
buffer_load_dwordx4 v200, s[16:19], s51 offen lds
s_add_u32 s50, s45, 10240
s_add_u32 s51, s43, 163840
s_mov_b32 m0, s50
s_nop 0
buffer_load_dwordx4 v200, s[16:19], s51 offen lds
s_add_u32 s50, s45, 11264
s_add_u32 s51, s43, 180224
s_mov_b32 m0, s50
s_nop 0
buffer_load_dwordx4 v200, s[16:19], s51 offen lds
s_add_u32 s50, s45, 12288
s_add_u32 s51, s43, 196608
s_mov_b32 m0, s50
s_nop 0
buffer_load_dwordx4 v200, s[16:19], s51 offen lds
s_add_u32 s50, s45, 13312
s_add_u32 s51, s43, 212992
s_mov_b32 m0, s50
s_nop 0
buffer_load_dwordx4 v200, s[16:19], s51 offen lds
s_add_u32 s50, s45, 14336
s_add_u32 s51, s43, 229376
s_mov_b32 m0, s50
s_nop 0
buffer_load_dwordx4 v200, s[16:19], s51 offen lds
s_add_u32 s50, s45, 15360
s_add_u32 s51, s43, 245760
s_mov_b32 m0, s50
s_nop 0
buffer_load_dwordx4 v200, s[16:19], s51 offen lds
s_mov_b32 s51, 8192
buffer_load_dwordx4 v[80:83], v201, s[24:27], s51 offen
buffer_load_dwordx4 v[84:87], v202, s[24:27], s51 offen
s_mov_b32 s51, 9216
buffer_load_dwordx4 v[88:91], v201, s[24:27], s51 offen
buffer_load_dwordx4 v[92:95], v202, s[24:27], s51 offen
s_mov_b32 s51, 10240
buffer_load_dwordx4 v[96:99], v201, s[24:27], s51 offen
buffer_load_dwordx4 v[100:103], v202, s[24:27], s51 offen
s_mov_b32 s51, 11264
buffer_load_dwordx4 v[104:107], v201, s[24:27], s51 offen
buffer_load_dwordx4 v[108:111], v202, s[24:27], s51 offen
s_mov_b32 s51, 12288
buffer_load_dwordx4 v[112:115], v201, s[24:27], s51 offen
buffer_load_dwordx4 v[116:119], v202, s[24:27], s51 offen
s_mov_b32 s51, 13312
buffer_load_dwordx4 v[120:123], v201, s[24:27], s51 offen
buffer_load_dwordx4 v[124:127], v202, s[24:27], s51 offen
s_mov_b32 s51, 14336
buffer_load_dwordx4 v[128:131], v201, s[24:27], s51 offen
buffer_load_dwordx4 v[132:135], v202, s[24:27], s51 offen
s_mov_b32 s51, 15360
buffer_load_dwordx4 v[136:139], v201, s[24:27], s51 offen
buffer_load_dwordx4 v[140:143], v202, s[24:27], s51 offen
s_waitcnt vmcnt(24)
ds_read_b64_tr_b16 v[208:209], v203 offset:0
ds_read_b64_tr_b16 v[210:211], v203 offset:256
ds_read_b64_tr_b16 v[212:213], v203 offset:1024
ds_read_b64_tr_b16 v[214:215], v203 offset:1280
ds_read_b64_tr_b16 v[216:217], v203 offset:2048
ds_read_b64_tr_b16 v[218:219], v203 offset:2304
s_waitcnt lgkmcnt(4)
v_mfma_f32_32x32x16_bf16 v[160:175], v[208:211], v[16:19], v[160:175]
v_mfma_f32_32x32x16_bf16 v[176:191], v[208:211], v[20:23], v[176:191]
ds_read_b64_tr_b16 v[220:221], v203 offset:3072
ds_read_b64_tr_b16 v[222:223], v203 offset:3328
s_waitcnt lgkmcnt(4)
v_mfma_f32_32x32x16_bf16 v[160:175], v[212:215], v[24:27], v[160:175]
v_mfma_f32_32x32x16_bf16 v[176:191], v[212:215], v[28:31], v[176:191]
ds_read_b64_tr_b16 v[208:209], v203 offset:4096
ds_read_b64_tr_b16 v[210:211], v203 offset:4352
s_waitcnt lgkmcnt(4)
v_mfma_f32_32x32x16_bf16 v[160:175], v[216:219], v[32:35], v[160:175]
v_mfma_f32_32x32x16_bf16 v[176:191], v[216:219], v[36:39], v[176:191]
ds_read_b64_tr_b16 v[212:213], v203 offset:5120
ds_read_b64_tr_b16 v[214:215], v203 offset:5376
s_waitcnt lgkmcnt(4)
v_mfma_f32_32x32x16_bf16 v[160:175], v[220:223], v[40:43], v[160:175]
v_mfma_f32_32x32x16_bf16 v[176:191], v[220:223], v[44:47], v[176:191]
ds_read_b64_tr_b16 v[216:217], v203 offset:6144
ds_read_b64_tr_b16 v[218:219], v203 offset:6400
s_waitcnt lgkmcnt(4)
v_mfma_f32_32x32x16_bf16 v[160:175], v[208:211], v[48:51], v[160:175]
v_mfma_f32_32x32x16_bf16 v[176:191], v[208:211], v[52:55], v[176:191]
ds_read_b64_tr_b16 v[220:221], v203 offset:7168
ds_read_b64_tr_b16 v[222:223], v203 offset:7424
s_waitcnt lgkmcnt(4)
v_mfma_f32_32x32x16_bf16 v[160:175], v[212:215], v[56:59], v[160:175]
v_mfma_f32_32x32x16_bf16 v[176:191], v[212:215], v[60:63], v[176:191]
s_waitcnt lgkmcnt(2)
v_mfma_f32_32x32x16_bf16 v[160:175], v[216:219], v[64:67], v[160:175]
v_mfma_f32_32x32x16_bf16 v[176:191], v[216:219], v[68:71], v[176:191]
s_waitcnt lgkmcnt(0)
v_mfma_f32_32x32x16_bf16 v[160:175], v[220:223], v[72:75], v[160:175]
v_mfma_f32_32x32x16_bf16 v[176:191], v[220:223], v[76:79], v[176:191]
s_add_u32 s50, s45, 0
s_add_u32 s51, s43, 262144
s_mov_b32 m0, s50
s_nop 0
buffer_load_dwordx4 v200, s[16:19], s51 offen lds
s_add_u32 s50, s45, 1024
s_add_u32 s51, s43, 278528
s_mov_b32 m0, s50
s_nop 0
buffer_load_dwordx4 v200, s[16:19], s51 offen lds
s_add_u32 s50, s45, 2048
s_add_u32 s51, s43, 294912
s_mov_b32 m0, s50
s_nop 0
buffer_load_dwordx4 v200, s[16:19], s51 offen lds
s_add_u32 s50, s45, 3072
s_add_u32 s51, s43, 311296
s_mov_b32 m0, s50
s_nop 0
buffer_load_dwordx4 v200, s[16:19], s51 offen lds
s_add_u32 s50, s45, 4096
s_add_u32 s51, s43, 327680
s_mov_b32 m0, s50
s_nop 0
buffer_load_dwordx4 v200, s[16:19], s51 offen lds
s_add_u32 s50, s45, 5120
s_add_u32 s51, s43, 344064
s_mov_b32 m0, s50
s_nop 0
buffer_load_dwordx4 v200, s[16:19], s51 offen lds
s_add_u32 s50, s45, 6144
s_add_u32 s51, s43, 360448
s_mov_b32 m0, s50
s_nop 0
buffer_load_dwordx4 v200, s[16:19], s51 offen lds
s_add_u32 s50, s45, 7168
s_add_u32 s51, s43, 376832
s_mov_b32 m0, s50
s_nop 0
buffer_load_dwordx4 v200, s[16:19], s51 offen lds
s_mov_b32 s51, 16384
buffer_load_dwordx4 v[16:19], v201, s[24:27], s51 offen
buffer_load_dwordx4 v[20:23], v202, s[24:27], s51 offen
s_mov_b32 s51, 17408
buffer_load_dwordx4 v[24:27], v201, s[24:27], s51 offen
buffer_load_dwordx4 v[28:31], v202, s[24:27], s51 offen
s_mov_b32 s51, 18432
buffer_load_dwordx4 v[32:35], v201, s[24:27], s51 offen
buffer_load_dwordx4 v[36:39], v202, s[24:27], s51 offen
s_mov_b32 s51, 19456
buffer_load_dwordx4 v[40:43], v201, s[24:27], s51 offen
buffer_load_dwordx4 v[44:47], v202, s[24:27], s51 offen
s_mov_b32 s51, 20480
buffer_load_dwordx4 v[48:51], v201, s[24:27], s51 offen
buffer_load_dwordx4 v[52:55], v202, s[24:27], s51 offen
s_mov_b32 s51, 21504
buffer_load_dwordx4 v[56:59], v201, s[24:27], s51 offen
buffer_load_dwordx4 v[60:63], v202, s[24:27], s51 offen
s_mov_b32 s51, 22528
buffer_load_dwordx4 v[64:67], v201, s[24:27], s51 offen
buffer_load_dwordx4 v[68:71], v202, s[24:27], s51 offen
s_mov_b32 s51, 23552
buffer_load_dwordx4 v[72:75], v201, s[24:27], s51 offen
buffer_load_dwordx4 v[76:79], v202, s[24:27], s51 offen
s_waitcnt vmcnt(24)
ds_read_b64_tr_b16 v[208:209], v203 offset:8192
ds_read_b64_tr_b16 v[210:211], v203 offset:8448
ds_read_b64_tr_b16 v[212:213], v203 offset:9216
ds_read_b64_tr_b16 v[214:215], v203 offset:9472
ds_read_b64_tr_b16 v[216:217], v203 offset:10240
ds_read_b64_tr_b16 v[218:219], v203 offset:10496
s_waitcnt lgkmcnt(4)
v_mfma_f32_32x32x16_bf16 v[160:175], v[208:211], v[80:83], v[160:175]
v_mfma_f32_32x32x16_bf16 v[176:191], v[208:211], v[84:87], v[176:191]
ds_read_b64_tr_b16 v[220:221], v203 offset:11264
ds_read_b64_tr_b16 v[222:223], v203 offset:11520
s_waitcnt lgkmcnt(4)
v_mfma_f32_32x32x16_bf16 v[160:175], v[212:215], v[88:91], v[160:175]
v_mfma_f32_32x32x16_bf16 v[176:191], v[212:215], v[92:95], v[176:191]
ds_read_b64_tr_b16 v[208:209], v203 offset:12288
ds_read_b64_tr_b16 v[210:211], v203 offset:12544
s_waitcnt lgkmcnt(4)
v_mfma_f32_32x32x16_bf16 v[160:175], v[216:219], v[96:99], v[160:175]
v_mfma_f32_32x32x16_bf16 v[176:191], v[216:219], v[100:103], v[176:191]
ds_read_b64_tr_b16 v[212:213], v203 offset:13312
ds_read_b64_tr_b16 v[214:215], v203 offset:13568
s_waitcnt lgkmcnt(4)
v_mfma_f32_32x32x16_bf16 v[160:175], v[220:223], v[104:107], v[160:175]
v_mfma_f32_32x32x16_bf16 v[176:191], v[220:223], v[108:111], v[176:191]
ds_read_b64_tr_b16 v[216:217], v203 offset:14336
ds_read_b64_tr_b16 v[218:219], v203 offset:14592
s_waitcnt lgkmcnt(4)
v_mfma_f32_32x32x16_bf16 v[160:175], v[208:211], v[112:115], v[160:175]
v_mfma_f32_32x32x16_bf16 v[176:191], v[208:211], v[116:119], v[176:191]
ds_read_b64_tr_b16 v[220:221], v203 offset:15360
ds_read_b64_tr_b16 v[222:223], v203 offset:15616
s_waitcnt lgkmcnt(4)
v_mfma_f32_32x32x16_bf16 v[160:175], v[212:215], v[120:123], v[160:175]
v_mfma_f32_32x32x16_bf16 v[176:191], v[212:215], v[124:127], v[176:191]
s_waitcnt lgkmcnt(2)
v_mfma_f32_32x32x16_bf16 v[160:175], v[216:219], v[128:131], v[160:175]
v_mfma_f32_32x32x16_bf16 v[176:191], v[216:219], v[132:135], v[176:191]
s_waitcnt lgkmcnt(0)
v_mfma_f32_32x32x16_bf16 v[160:175], v[220:223], v[136:139], v[160:175]
v_mfma_f32_32x32x16_bf16 v[176:191], v[220:223], v[140:143], v[176:191]
s_add_u32 s50, s45, 8192
s_add_u32 s51, s43, 393216
s_mov_b32 m0, s50
s_nop 0
buffer_load_dwordx4 v200, s[16:19], s51 offen lds
s_add_u32 s50, s45, 9216
s_add_u32 s51, s43, 409600
s_mov_b32 m0, s50
s_nop 0
buffer_load_dwordx4 v200, s[16:19], s51 offen lds
s_add_u32 s50, s45, 10240
s_add_u32 s51, s43, 425984
s_mov_b32 m0, s50
s_nop 0
buffer_load_dwordx4 v200, s[16:19], s51 offen lds
s_add_u32 s50, s45, 11264
s_add_u32 s51, s43, 442368
s_mov_b32 m0, s50
s_nop 0
buffer_load_dwordx4 v200, s[16:19], s51 offen lds
s_add_u32 s50, s45, 12288
s_add_u32 s51, s43, 458752
s_mov_b32 m0, s50
s_nop 0
buffer_load_dwordx4 v200, s[16:19], s51 offen lds
s_add_u32 s50, s45, 13312
s_add_u32 s51, s43, 475136
s_mov_b32 m0, s50
s_nop 0
buffer_load_dwordx4 v200, s[16:19], s51 offen lds
s_add_u32 s50, s45, 14336
s_add_u32 s51, s43, 491520
s_mov_b32 m0, s50
s_nop 0
buffer_load_dwordx4 v200, s[16:19], s51 offen lds
s_add_u32 s50, s45, 15360
s_add_u32 s51, s43, 507904
s_mov_b32 m0, s50
s_nop 0
buffer_load_dwordx4 v200, s[16:19], s51 offen lds
s_mov_b32 s51, 24576
buffer_load_dwordx4 v[80:83], v201, s[24:27], s51 offen
buffer_load_dwordx4 v[84:87], v202, s[24:27], s51 offen
s_mov_b32 s51, 25600
buffer_load_dwordx4 v[88:91], v201, s[24:27], s51 offen
buffer_load_dwordx4 v[92:95], v202, s[24:27], s51 offen
s_mov_b32 s51, 26624
buffer_load_dwordx4 v[96:99], v201, s[24:27], s51 offen
buffer_load_dwordx4 v[100:103], v202, s[24:27], s51 offen
s_mov_b32 s51, 27648
buffer_load_dwordx4 v[104:107], v201, s[24:27], s51 offen
buffer_load_dwordx4 v[108:111], v202, s[24:27], s51 offen
s_mov_b32 s51, 28672
buffer_load_dwordx4 v[112:115], v201, s[24:27], s51 offen
buffer_load_dwordx4 v[116:119], v202, s[24:27], s51 offen
s_mov_b32 s51, 29696
buffer_load_dwordx4 v[120:123], v201, s[24:27], s51 offen
buffer_load_dwordx4 v[124:127], v202, s[24:27], s51 offen
s_mov_b32 s51, 30720
buffer_load_dwordx4 v[128:131], v201, s[24:27], s51 offen
buffer_load_dwordx4 v[132:135], v202, s[24:27], s51 offen
s_mov_b32 s51, 31744
buffer_load_dwordx4 v[136:139], v201, s[24:27], s51 offen
buffer_load_dwordx4 v[140:143], v202, s[24:27], s51 offen
s_waitcnt vmcnt(24)
ds_read_b64_tr_b16 v[208:209], v203 offset:0
ds_read_b64_tr_b16 v[210:211], v203 offset:256
ds_read_b64_tr_b16 v[212:213], v203 offset:1024
ds_read_b64_tr_b16 v[214:215], v203 offset:1280
ds_read_b64_tr_b16 v[216:217], v203 offset:2048
ds_read_b64_tr_b16 v[218:219], v203 offset:2304
s_waitcnt lgkmcnt(4)
v_mfma_f32_32x32x16_bf16 v[160:175], v[208:211], v[16:19], v[160:175]
v_mfma_f32_32x32x16_bf16 v[176:191], v[208:211], v[20:23], v[176:191]
ds_read_b64_tr_b16 v[220:221], v203 offset:3072
ds_read_b64_tr_b16 v[222:223], v203 offset:3328
s_waitcnt lgkmcnt(4)
v_mfma_f32_32x32x16_bf16 v[160:175], v[212:215], v[24:27], v[160:175]
v_mfma_f32_32x32x16_bf16 v[176:191], v[212:215], v[28:31], v[176:191]
ds_read_b64_tr_b16 v[208:209], v203 offset:4096
ds_read_b64_tr_b16 v[210:211], v203 offset:4352
s_waitcnt lgkmcnt(4)
v_mfma_f32_32x32x16_bf16 v[160:175], v[216:219], v[32:35], v[160:175]
v_mfma_f32_32x32x16_bf16 v[176:191], v[216:219], v[36:39], v[176:191]
ds_read_b64_tr_b16 v[212:213], v203 offset:5120
ds_read_b64_tr_b16 v[214:215], v203 offset:5376
s_waitcnt lgkmcnt(4)
v_mfma_f32_32x32x16_bf16 v[160:175], v[220:223], v[40:43], v[160:175]
v_mfma_f32_32x32x16_bf16 v[176:191], v[220:223], v[44:47], v[176:191]
ds_read_b64_tr_b16 v[216:217], v203 offset:6144
ds_read_b64_tr_b16 v[218:219], v203 offset:6400
s_waitcnt lgkmcnt(4)
v_mfma_f32_32x32x16_bf16 v[160:175], v[208:211], v[48:51], v[160:175]
v_mfma_f32_32x32x16_bf16 v[176:191], v[208:211], v[52:55], v[176:191]
ds_read_b64_tr_b16 v[220:221], v203 offset:7168
ds_read_b64_tr_b16 v[222:223], v203 offset:7424
s_waitcnt lgkmcnt(4)
v_mfma_f32_32x32x16_bf16 v[160:175], v[212:215], v[56:59], v[160:175]
v_mfma_f32_32x32x16_bf16 v[176:191], v[212:215], v[60:63], v[176:191]
s_waitcnt lgkmcnt(2)
v_mfma_f32_32x32x16_bf16 v[160:175], v[216:219], v[64:67], v[160:175]
v_mfma_f32_32x32x16_bf16 v[176:191], v[216:219], v[68:71], v[176:191]
s_waitcnt lgkmcnt(0)
v_mfma_f32_32x32x16_bf16 v[160:175], v[220:223], v[72:75], v[160:175]
v_mfma_f32_32x32x16_bf16 v[176:191], v[220:223], v[76:79], v[176:191]
s_add_u32 s50, s45, 0
s_add_u32 s51, s43, 524288
s_mov_b32 m0, s50
s_nop 0
buffer_load_dwordx4 v200, s[16:19], s51 offen lds
s_add_u32 s50, s45, 1024
s_add_u32 s51, s43, 540672
s_mov_b32 m0, s50
s_nop 0
buffer_load_dwordx4 v200, s[16:19], s51 offen lds
s_add_u32 s50, s45, 2048
s_add_u32 s51, s43, 557056
s_mov_b32 m0, s50
s_nop 0
buffer_load_dwordx4 v200, s[16:19], s51 offen lds
s_add_u32 s50, s45, 3072
s_add_u32 s51, s43, 573440
s_mov_b32 m0, s50
s_nop 0
buffer_load_dwordx4 v200, s[16:19], s51 offen lds
s_add_u32 s50, s45, 4096
s_add_u32 s51, s43, 589824
s_mov_b32 m0, s50
s_nop 0
buffer_load_dwordx4 v200, s[16:19], s51 offen lds
s_add_u32 s50, s45, 5120
s_add_u32 s51, s43, 606208
s_mov_b32 m0, s50
s_nop 0
buffer_load_dwordx4 v200, s[16:19], s51 offen lds
s_add_u32 s50, s45, 6144
s_add_u32 s51, s43, 622592
s_mov_b32 m0, s50
s_nop 0
buffer_load_dwordx4 v200, s[16:19], s51 offen lds
s_add_u32 s50, s45, 7168
s_add_u32 s51, s43, 638976
s_mov_b32 m0, s50
s_nop 0
buffer_load_dwordx4 v200, s[16:19], s51 offen lds
s_mov_b32 s51, 32768
buffer_load_dwordx4 v[16:19], v201, s[24:27], s51 offen
buffer_load_dwordx4 v[20:23], v202, s[24:27], s51 offen
s_mov_b32 s51, 33792
buffer_load_dwordx4 v[24:27], v201, s[24:27], s51 offen
buffer_load_dwordx4 v[28:31], v202, s[24:27], s51 offen
s_mov_b32 s51, 34816
buffer_load_dwordx4 v[32:35], v201, s[24:27], s51 offen
buffer_load_dwordx4 v[36:39], v202, s[24:27], s51 offen
s_mov_b32 s51, 35840
buffer_load_dwordx4 v[40:43], v201, s[24:27], s51 offen
buffer_load_dwordx4 v[44:47], v202, s[24:27], s51 offen
s_mov_b32 s51, 36864
buffer_load_dwordx4 v[48:51], v201, s[24:27], s51 offen
buffer_load_dwordx4 v[52:55], v202, s[24:27], s51 offen
s_mov_b32 s51, 37888
buffer_load_dwordx4 v[56:59], v201, s[24:27], s51 offen
buffer_load_dwordx4 v[60:63], v202, s[24:27], s51 offen
s_mov_b32 s51, 38912
buffer_load_dwordx4 v[64:67], v201, s[24:27], s51 offen
buffer_load_dwordx4 v[68:71], v202, s[24:27], s51 offen
s_mov_b32 s51, 39936
buffer_load_dwordx4 v[72:75], v201, s[24:27], s51 offen
buffer_load_dwordx4 v[76:79], v202, s[24:27], s51 offen
s_waitcnt vmcnt(24)
ds_read_b64_tr_b16 v[208:209], v203 offset:8192
ds_read_b64_tr_b16 v[210:211], v203 offset:8448
ds_read_b64_tr_b16 v[212:213], v203 offset:9216
ds_read_b64_tr_b16 v[214:215], v203 offset:9472
ds_read_b64_tr_b16 v[216:217], v203 offset:10240
ds_read_b64_tr_b16 v[218:219], v203 offset:10496
s_waitcnt lgkmcnt(4)
v_mfma_f32_32x32x16_bf16 v[160:175], v[208:211], v[80:83], v[160:175]
v_mfma_f32_32x32x16_bf16 v[176:191], v[208:211], v[84:87], v[176:191]
ds_read_b64_tr_b16 v[220:221], v203 offset:11264
ds_read_b64_tr_b16 v[222:223], v203 offset:11520
s_waitcnt lgkmcnt(4)
v_mfma_f32_32x32x16_bf16 v[160:175], v[212:215], v[88:91], v[160:175]
v_mfma_f32_32x32x16_bf16 v[176:191], v[212:215], v[92:95], v[176:191]
ds_read_b64_tr_b16 v[208:209], v203 offset:12288
ds_read_b64_tr_b16 v[210:211], v203 offset:12544
s_waitcnt lgkmcnt(4)
v_mfma_f32_32x32x16_bf16 v[160:175], v[216:219], v[96:99], v[160:175]
v_mfma_f32_32x32x16_bf16 v[176:191], v[216:219], v[100:103], v[176:191]
ds_read_b64_tr_b16 v[212:213], v203 offset:13312
ds_read_b64_tr_b16 v[214:215], v203 offset:13568
s_waitcnt lgkmcnt(4)
v_mfma_f32_32x32x16_bf16 v[160:175], v[220:223], v[104:107], v[160:175]
v_mfma_f32_32x32x16_bf16 v[176:191], v[220:223], v[108:111], v[176:191]
ds_read_b64_tr_b16 v[216:217], v203 offset:14336
ds_read_b64_tr_b16 v[218:219], v203 offset:14592
s_waitcnt lgkmcnt(4)
v_mfma_f32_32x32x16_bf16 v[160:175], v[208:211], v[112:115], v[160:175]
v_mfma_f32_32x32x16_bf16 v[176:191], v[208:211], v[116:119], v[176:191]
ds_read_b64_tr_b16 v[220:221], v203 offset:15360
ds_read_b64_tr_b16 v[222:223], v203 offset:15616
s_waitcnt lgkmcnt(4)
v_mfma_f32_32x32x16_bf16 v[160:175], v[212:215], v[120:123], v[160:175]
v_mfma_f32_32x32x16_bf16 v[176:191], v[212:215], v[124:127], v[176:191]
s_waitcnt lgkmcnt(2)
v_mfma_f32_32x32x16_bf16 v[160:175], v[216:219], v[128:131], v[160:175]
v_mfma_f32_32x32x16_bf16 v[176:191], v[216:219], v[132:135], v[176:191]
s_waitcnt lgkmcnt(0)
v_mfma_f32_32x32x16_bf16 v[160:175], v[220:223], v[136:139], v[160:175]
v_mfma_f32_32x32x16_bf16 v[176:191], v[220:223], v[140:143], v[176:191]
s_add_u32 s50, s45, 8192
s_add_u32 s51, s43, 655360
s_mov_b32 m0, s50
s_nop 0
buffer_load_dwordx4 v200, s[16:19], s51 offen lds
s_add_u32 s50, s45, 9216
s_add_u32 s51, s43, 671744
s_mov_b32 m0, s50
s_nop 0
buffer_load_dwordx4 v200, s[16:19], s51 offen lds
s_add_u32 s50, s45, 10240
s_add_u32 s51, s43, 688128
s_mov_b32 m0, s50
s_nop 0
buffer_load_dwordx4 v200, s[16:19], s51 offen lds
s_add_u32 s50, s45, 11264
s_add_u32 s51, s43, 704512
s_mov_b32 m0, s50
s_nop 0
buffer_load_dwordx4 v200, s[16:19], s51 offen lds
s_add_u32 s50, s45, 12288
s_add_u32 s51, s43, 720896
s_mov_b32 m0, s50
s_nop 0
buffer_load_dwordx4 v200, s[16:19], s51 offen lds
s_add_u32 s50, s45, 13312
s_add_u32 s51, s43, 737280
s_mov_b32 m0, s50
s_nop 0
buffer_load_dwordx4 v200, s[16:19], s51 offen lds
s_add_u32 s50, s45, 14336
s_add_u32 s51, s43, 753664
s_mov_b32 m0, s50
s_nop 0
buffer_load_dwordx4 v200, s[16:19], s51 offen lds
s_add_u32 s50, s45, 15360
s_add_u32 s51, s43, 770048
s_mov_b32 m0, s50
s_nop 0
buffer_load_dwordx4 v200, s[16:19], s51 offen lds
s_mov_b32 s51, 40960
buffer_load_dwordx4 v[80:83], v201, s[24:27], s51 offen
buffer_load_dwordx4 v[84:87], v202, s[24:27], s51 offen
s_mov_b32 s51, 41984
buffer_load_dwordx4 v[88:91], v201, s[24:27], s51 offen
buffer_load_dwordx4 v[92:95], v202, s[24:27], s51 offen
s_mov_b32 s51, 43008
buffer_load_dwordx4 v[96:99], v201, s[24:27], s51 offen
buffer_load_dwordx4 v[100:103], v202, s[24:27], s51 offen
s_mov_b32 s51, 44032
buffer_load_dwordx4 v[104:107], v201, s[24:27], s51 offen
buffer_load_dwordx4 v[108:111], v202, s[24:27], s51 offen
s_mov_b32 s51, 45056
buffer_load_dwordx4 v[112:115], v201, s[24:27], s51 offen
buffer_load_dwordx4 v[116:119], v202, s[24:27], s51 offen
s_mov_b32 s51, 46080
buffer_load_dwordx4 v[120:123], v201, s[24:27], s51 offen
buffer_load_dwordx4 v[124:127], v202, s[24:27], s51 offen
s_mov_b32 s51, 47104
buffer_load_dwordx4 v[128:131], v201, s[24:27], s51 offen
buffer_load_dwordx4 v[132:135], v202, s[24:27], s51 offen
s_mov_b32 s51, 48128
buffer_load_dwordx4 v[136:139], v201, s[24:27], s51 offen
buffer_load_dwordx4 v[140:143], v202, s[24:27], s51 offen
s_waitcnt vmcnt(24)
ds_read_b64_tr_b16 v[208:209], v203 offset:0
ds_read_b64_tr_b16 v[210:211], v203 offset:256
ds_read_b64_tr_b16 v[212:213], v203 offset:1024
ds_read_b64_tr_b16 v[214:215], v203 offset:1280
ds_read_b64_tr_b16 v[216:217], v203 offset:2048
ds_read_b64_tr_b16 v[218:219], v203 offset:2304
s_waitcnt lgkmcnt(4)
v_mfma_f32_32x32x16_bf16 v[160:175], v[208:211], v[16:19], v[160:175]
v_mfma_f32_32x32x16_bf16 v[176:191], v[208:211], v[20:23], v[176:191]
ds_read_b64_tr_b16 v[220:221], v203 offset:3072
ds_read_b64_tr_b16 v[222:223], v203 offset:3328
s_waitcnt lgkmcnt(4)
v_mfma_f32_32x32x16_bf16 v[160:175], v[212:215], v[24:27], v[160:175]
v_mfma_f32_32x32x16_bf16 v[176:191], v[212:215], v[28:31], v[176:191]
ds_read_b64_tr_b16 v[208:209], v203 offset:4096
ds_read_b64_tr_b16 v[210:211], v203 offset:4352
s_waitcnt lgkmcnt(4)
v_mfma_f32_32x32x16_bf16 v[160:175], v[216:219], v[32:35], v[160:175]
v_mfma_f32_32x32x16_bf16 v[176:191], v[216:219], v[36:39], v[176:191]
ds_read_b64_tr_b16 v[212:213], v203 offset:5120
ds_read_b64_tr_b16 v[214:215], v203 offset:5376
s_waitcnt lgkmcnt(4)
v_mfma_f32_32x32x16_bf16 v[160:175], v[220:223], v[40:43], v[160:175]
v_mfma_f32_32x32x16_bf16 v[176:191], v[220:223], v[44:47], v[176:191]
ds_read_b64_tr_b16 v[216:217], v203 offset:6144
ds_read_b64_tr_b16 v[218:219], v203 offset:6400
s_waitcnt lgkmcnt(4)
v_mfma_f32_32x32x16_bf16 v[160:175], v[208:211], v[48:51], v[160:175]
v_mfma_f32_32x32x16_bf16 v[176:191], v[208:211], v[52:55], v[176:191]
ds_read_b64_tr_b16 v[220:221], v203 offset:7168
ds_read_b64_tr_b16 v[222:223], v203 offset:7424
s_waitcnt lgkmcnt(4)
v_mfma_f32_32x32x16_bf16 v[160:175], v[212:215], v[56:59], v[160:175]
v_mfma_f32_32x32x16_bf16 v[176:191], v[212:215], v[60:63], v[176:191]
s_waitcnt lgkmcnt(2)
v_mfma_f32_32x32x16_bf16 v[160:175], v[216:219], v[64:67], v[160:175]
v_mfma_f32_32x32x16_bf16 v[176:191], v[216:219], v[68:71], v[176:191]
s_waitcnt lgkmcnt(0)
v_mfma_f32_32x32x16_bf16 v[160:175], v[220:223], v[72:75], v[160:175]
v_mfma_f32_32x32x16_bf16 v[176:191], v[220:223], v[76:79], v[176:191]
s_add_u32 s50, s45, 0
s_add_u32 s51, s43, 786432
s_mov_b32 m0, s50
s_nop 0
buffer_load_dwordx4 v200, s[16:19], s51 offen lds
s_add_u32 s50, s45, 1024
s_add_u32 s51, s43, 802816
s_mov_b32 m0, s50
s_nop 0
buffer_load_dwordx4 v200, s[16:19], s51 offen lds
s_add_u32 s50, s45, 2048
s_add_u32 s51, s43, 819200
s_mov_b32 m0, s50
s_nop 0
buffer_load_dwordx4 v200, s[16:19], s51 offen lds
s_add_u32 s50, s45, 3072
s_add_u32 s51, s43, 835584
s_mov_b32 m0, s50
s_nop 0
buffer_load_dwordx4 v200, s[16:19], s51 offen lds
s_add_u32 s50, s45, 4096
s_add_u32 s51, s43, 851968
s_mov_b32 m0, s50
s_nop 0
buffer_load_dwordx4 v200, s[16:19], s51 offen lds
s_add_u32 s50, s45, 5120
s_add_u32 s51, s43, 868352
s_mov_b32 m0, s50
s_nop 0
buffer_load_dwordx4 v200, s[16:19], s51 offen lds
s_add_u32 s50, s45, 6144
s_add_u32 s51, s43, 884736
s_mov_b32 m0, s50
s_nop 0
buffer_load_dwordx4 v200, s[16:19], s51 offen lds
s_add_u32 s50, s45, 7168
s_add_u32 s51, s43, 901120
s_mov_b32 m0, s50
s_nop 0
buffer_load_dwordx4 v200, s[16:19], s51 offen lds
s_mov_b32 s51, 49152
buffer_load_dwordx4 v[16:19], v201, s[24:27], s51 offen
buffer_load_dwordx4 v[20:23], v202, s[24:27], s51 offen
s_mov_b32 s51, 50176
buffer_load_dwordx4 v[24:27], v201, s[24:27], s51 offen
buffer_load_dwordx4 v[28:31], v202, s[24:27], s51 offen
s_mov_b32 s51, 51200
buffer_load_dwordx4 v[32:35], v201, s[24:27], s51 offen
buffer_load_dwordx4 v[36:39], v202, s[24:27], s51 offen
s_mov_b32 s51, 52224
buffer_load_dwordx4 v[40:43], v201, s[24:27], s51 offen
buffer_load_dwordx4 v[44:47], v202, s[24:27], s51 offen
s_mov_b32 s51, 53248
buffer_load_dwordx4 v[48:51], v201, s[24:27], s51 offen
buffer_load_dwordx4 v[52:55], v202, s[24:27], s51 offen
s_mov_b32 s51, 54272
buffer_load_dwordx4 v[56:59], v201, s[24:27], s51 offen
buffer_load_dwordx4 v[60:63], v202, s[24:27], s51 offen
s_mov_b32 s51, 55296
buffer_load_dwordx4 v[64:67], v201, s[24:27], s51 offen
buffer_load_dwordx4 v[68:71], v202, s[24:27], s51 offen
s_mov_b32 s51, 56320
buffer_load_dwordx4 v[72:75], v201, s[24:27], s51 offen
buffer_load_dwordx4 v[76:79], v202, s[24:27], s51 offen
s_waitcnt vmcnt(24)
ds_read_b64_tr_b16 v[208:209], v203 offset:8192
ds_read_b64_tr_b16 v[210:211], v203 offset:8448
ds_read_b64_tr_b16 v[212:213], v203 offset:9216
ds_read_b64_tr_b16 v[214:215], v203 offset:9472
ds_read_b64_tr_b16 v[216:217], v203 offset:10240
ds_read_b64_tr_b16 v[218:219], v203 offset:10496
s_waitcnt lgkmcnt(4)
v_mfma_f32_32x32x16_bf16 v[160:175], v[208:211], v[80:83], v[160:175]
v_mfma_f32_32x32x16_bf16 v[176:191], v[208:211], v[84:87], v[176:191]
ds_read_b64_tr_b16 v[220:221], v203 offset:11264
ds_read_b64_tr_b16 v[222:223], v203 offset:11520
s_waitcnt lgkmcnt(4)
v_mfma_f32_32x32x16_bf16 v[160:175], v[212:215], v[88:91], v[160:175]
v_mfma_f32_32x32x16_bf16 v[176:191], v[212:215], v[92:95], v[176:191]
ds_read_b64_tr_b16 v[208:209], v203 offset:12288
ds_read_b64_tr_b16 v[210:211], v203 offset:12544
s_waitcnt lgkmcnt(4)
v_mfma_f32_32x32x16_bf16 v[160:175], v[216:219], v[96:99], v[160:175]
v_mfma_f32_32x32x16_bf16 v[176:191], v[216:219], v[100:103], v[176:191]
ds_read_b64_tr_b16 v[212:213], v203 offset:13312
ds_read_b64_tr_b16 v[214:215], v203 offset:13568
s_waitcnt lgkmcnt(4)
v_mfma_f32_32x32x16_bf16 v[160:175], v[220:223], v[104:107], v[160:175]
v_mfma_f32_32x32x16_bf16 v[176:191], v[220:223], v[108:111], v[176:191]
ds_read_b64_tr_b16 v[216:217], v203 offset:14336
ds_read_b64_tr_b16 v[218:219], v203 offset:14592
s_waitcnt lgkmcnt(4)
v_mfma_f32_32x32x16_bf16 v[160:175], v[208:211], v[112:115], v[160:175]
v_mfma_f32_32x32x16_bf16 v[176:191], v[208:211], v[116:119], v[176:191]
ds_read_b64_tr_b16 v[220:221], v203 offset:15360
ds_read_b64_tr_b16 v[222:223], v203 offset:15616
s_waitcnt lgkmcnt(4)
v_mfma_f32_32x32x16_bf16 v[160:175], v[212:215], v[120:123], v[160:175]
v_mfma_f32_32x32x16_bf16 v[176:191], v[212:215], v[124:127], v[176:191]
s_waitcnt lgkmcnt(2)
v_mfma_f32_32x32x16_bf16 v[160:175], v[216:219], v[128:131], v[160:175]
v_mfma_f32_32x32x16_bf16 v[176:191], v[216:219], v[132:135], v[176:191]
s_waitcnt lgkmcnt(0)
v_mfma_f32_32x32x16_bf16 v[160:175], v[220:223], v[136:139], v[160:175]
v_mfma_f32_32x32x16_bf16 v[176:191], v[220:223], v[140:143], v[176:191]
s_add_u32 s50, s45, 8192
s_add_u32 s51, s43, 917504
s_mov_b32 m0, s50
s_nop 0
buffer_load_dwordx4 v200, s[16:19], s51 offen lds
s_add_u32 s50, s45, 9216
s_add_u32 s51, s43, 933888
s_mov_b32 m0, s50
s_nop 0
buffer_load_dwordx4 v200, s[16:19], s51 offen lds
s_add_u32 s50, s45, 10240
s_add_u32 s51, s43, 950272
s_mov_b32 m0, s50
s_nop 0
buffer_load_dwordx4 v200, s[16:19], s51 offen lds
s_add_u32 s50, s45, 11264
s_add_u32 s51, s43, 966656
s_mov_b32 m0, s50
s_nop 0
buffer_load_dwordx4 v200, s[16:19], s51 offen lds
s_add_u32 s50, s45, 12288
s_add_u32 s51, s43, 983040
s_mov_b32 m0, s50
s_nop 0
buffer_load_dwordx4 v200, s[16:19], s51 offen lds
s_add_u32 s50, s45, 13312
s_add_u32 s51, s43, 999424
s_mov_b32 m0, s50
s_nop 0
buffer_load_dwordx4 v200, s[16:19], s51 offen lds
s_add_u32 s50, s45, 14336
s_add_u32 s51, s43, 1015808
s_mov_b32 m0, s50
s_nop 0
buffer_load_dwordx4 v200, s[16:19], s51 offen lds
s_add_u32 s50, s45, 15360
s_add_u32 s51, s43, 1032192
s_mov_b32 m0, s50
s_nop 0
buffer_load_dwordx4 v200, s[16:19], s51 offen lds
s_mov_b32 s51, 57344
buffer_load_dwordx4 v[80:83], v201, s[24:27], s51 offen
buffer_load_dwordx4 v[84:87], v202, s[24:27], s51 offen
s_mov_b32 s51, 58368
buffer_load_dwordx4 v[88:91], v201, s[24:27], s51 offen
buffer_load_dwordx4 v[92:95], v202, s[24:27], s51 offen
s_mov_b32 s51, 59392
buffer_load_dwordx4 v[96:99], v201, s[24:27], s51 offen
buffer_load_dwordx4 v[100:103], v202, s[24:27], s51 offen
s_mov_b32 s51, 60416
buffer_load_dwordx4 v[104:107], v201, s[24:27], s51 offen
buffer_load_dwordx4 v[108:111], v202, s[24:27], s51 offen
s_mov_b32 s51, 61440
buffer_load_dwordx4 v[112:115], v201, s[24:27], s51 offen
buffer_load_dwordx4 v[116:119], v202, s[24:27], s51 offen
s_mov_b32 s51, 62464
buffer_load_dwordx4 v[120:123], v201, s[24:27], s51 offen
buffer_load_dwordx4 v[124:127], v202, s[24:27], s51 offen
s_mov_b32 s51, 63488
buffer_load_dwordx4 v[128:131], v201, s[24:27], s51 offen
buffer_load_dwordx4 v[132:135], v202, s[24:27], s51 offen
s_mov_b32 s51, 64512
buffer_load_dwordx4 v[136:139], v201, s[24:27], s51 offen
buffer_load_dwordx4 v[140:143], v202, s[24:27], s51 offen
s_waitcnt vmcnt(24)
ds_read_b64_tr_b16 v[208:209], v203 offset:0
ds_read_b64_tr_b16 v[210:211], v203 offset:256
ds_read_b64_tr_b16 v[212:213], v203 offset:1024
ds_read_b64_tr_b16 v[214:215], v203 offset:1280
ds_read_b64_tr_b16 v[216:217], v203 offset:2048
ds_read_b64_tr_b16 v[218:219], v203 offset:2304
s_waitcnt lgkmcnt(4)
v_mfma_f32_32x32x16_bf16 v[160:175], v[208:211], v[16:19], v[160:175]
v_mfma_f32_32x32x16_bf16 v[176:191], v[208:211], v[20:23], v[176:191]
ds_read_b64_tr_b16 v[220:221], v203 offset:3072
ds_read_b64_tr_b16 v[222:223], v203 offset:3328
s_waitcnt lgkmcnt(4)
v_mfma_f32_32x32x16_bf16 v[160:175], v[212:215], v[24:27], v[160:175]
v_mfma_f32_32x32x16_bf16 v[176:191], v[212:215], v[28:31], v[176:191]
ds_read_b64_tr_b16 v[208:209], v203 offset:4096
ds_read_b64_tr_b16 v[210:211], v203 offset:4352
s_waitcnt lgkmcnt(4)
v_mfma_f32_32x32x16_bf16 v[160:175], v[216:219], v[32:35], v[160:175]
v_mfma_f32_32x32x16_bf16 v[176:191], v[216:219], v[36:39], v[176:191]
ds_read_b64_tr_b16 v[212:213], v203 offset:5120
ds_read_b64_tr_b16 v[214:215], v203 offset:5376
s_waitcnt lgkmcnt(4)
v_mfma_f32_32x32x16_bf16 v[160:175], v[220:223], v[40:43], v[160:175]
v_mfma_f32_32x32x16_bf16 v[176:191], v[220:223], v[44:47], v[176:191]
ds_read_b64_tr_b16 v[216:217], v203 offset:6144
ds_read_b64_tr_b16 v[218:219], v203 offset:6400
s_waitcnt lgkmcnt(4)
v_mfma_f32_32x32x16_bf16 v[160:175], v[208:211], v[48:51], v[160:175]
v_mfma_f32_32x32x16_bf16 v[176:191], v[208:211], v[52:55], v[176:191]
ds_read_b64_tr_b16 v[220:221], v203 offset:7168
ds_read_b64_tr_b16 v[222:223], v203 offset:7424
s_waitcnt lgkmcnt(4)
v_mfma_f32_32x32x16_bf16 v[160:175], v[212:215], v[56:59], v[160:175]
v_mfma_f32_32x32x16_bf16 v[176:191], v[212:215], v[60:63], v[176:191]
s_waitcnt lgkmcnt(2)
v_mfma_f32_32x32x16_bf16 v[160:175], v[216:219], v[64:67], v[160:175]
v_mfma_f32_32x32x16_bf16 v[176:191], v[216:219], v[68:71], v[176:191]
s_waitcnt lgkmcnt(0)
v_mfma_f32_32x32x16_bf16 v[160:175], v[220:223], v[72:75], v[160:175]
v_mfma_f32_32x32x16_bf16 v[176:191], v[220:223], v[76:79], v[176:191]
s_waitcnt vmcnt(0)
ds_read_b64_tr_b16 v[208:209], v203 offset:8192
ds_read_b64_tr_b16 v[210:211], v203 offset:8448
ds_read_b64_tr_b16 v[212:213], v203 offset:9216
ds_read_b64_tr_b16 v[214:215], v203 offset:9472
ds_read_b64_tr_b16 v[216:217], v203 offset:10240
ds_read_b64_tr_b16 v[218:219], v203 offset:10496
s_waitcnt lgkmcnt(4)
v_mfma_f32_32x32x16_bf16 v[160:175], v[208:211], v[80:83], v[160:175]
v_mfma_f32_32x32x16_bf16 v[176:191], v[208:211], v[84:87], v[176:191]
ds_read_b64_tr_b16 v[220:221], v203 offset:11264
ds_read_b64_tr_b16 v[222:223], v203 offset:11520
s_waitcnt lgkmcnt(4)
v_mfma_f32_32x32x16_bf16 v[160:175], v[212:215], v[88:91], v[160:175]
v_mfma_f32_32x32x16_bf16 v[176:191], v[212:215], v[92:95], v[176:191]
ds_read_b64_tr_b16 v[208:209], v203 offset:12288
ds_read_b64_tr_b16 v[210:211], v203 offset:12544
s_waitcnt lgkmcnt(4)
v_mfma_f32_32x32x16_bf16 v[160:175], v[216:219], v[96:99], v[160:175]
v_mfma_f32_32x32x16_bf16 v[176:191], v[216:219], v[100:103], v[176:191]
ds_read_b64_tr_b16 v[212:213], v203 offset:13312
ds_read_b64_tr_b16 v[214:215], v203 offset:13568
s_waitcnt lgkmcnt(4)
v_mfma_f32_32x32x16_bf16 v[160:175], v[220:223], v[104:107], v[160:175]
v_mfma_f32_32x32x16_bf16 v[176:191], v[220:223], v[108:111], v[176:191]
ds_read_b64_tr_b16 v[216:217], v203 offset:14336
ds_read_b64_tr_b16 v[218:219], v203 offset:14592
s_waitcnt lgkmcnt(4)
v_mfma_f32_32x32x16_bf16 v[160:175], v[208:211], v[112:115], v[160:175]
v_mfma_f32_32x32x16_bf16 v[176:191], v[208:211], v[116:119], v[176:191]
ds_read_b64_tr_b16 v[220:221], v203 offset:15360
ds_read_b64_tr_b16 v[222:223], v203 offset:15616
s_waitcnt lgkmcnt(4)
v_mfma_f32_32x32x16_bf16 v[160:175], v[212:215], v[120:123], v[160:175]
v_mfma_f32_32x32x16_bf16 v[176:191], v[212:215], v[124:127], v[176:191]
s_waitcnt lgkmcnt(2)
v_mfma_f32_32x32x16_bf16 v[160:175], v[216:219], v[128:131], v[160:175]
v_mfma_f32_32x32x16_bf16 v[176:191], v[216:219], v[132:135], v[176:191]
s_waitcnt lgkmcnt(0)
v_mfma_f32_32x32x16_bf16 v[160:175], v[220:223], v[136:139], v[160:175]
v_mfma_f32_32x32x16_bf16 v[176:191], v[220:223], v[140:143], v[176:191]
s_nop 15
s_barrier
v_lshlrev_b32 v10, 4, v1
s_lshl_b32 s50, s40, 13
v_add_u32 v10, s50, v10
ds_write_b128 v10, v[160:163] offset:0
ds_write_b128 v10, v[164:167] offset:1024
ds_write_b128 v10, v[168:171] offset:2048
ds_write_b128 v10, v[172:175] offset:3072
ds_write_b128 v10, v[176:179] offset:4096
ds_write_b128 v10, v[180:183] offset:5120
ds_write_b128 v10, v[184:187] offset:6144
ds_write_b128 v10, v[188:191] offset:7168
s_waitcnt lgkmcnt(0)
s_barrier
v_lshlrev_b32 v10, 4, v1
s_lshl_b32 s50, s40, 11
v_add_u32 v10, s50, v10
ds_read_b128 v[16:19], v10 offset:0
ds_read_b128 v[20:23], v10 offset:1024
ds_read_b128 v[24:27], v10 offset:8192
ds_read_b128 v[28:31], v10 offset:9216
ds_read_b128 v[32:35], v10 offset:16384
ds_read_b128 v[36:39], v10 offset:17408
ds_read_b128 v[40:43], v10 offset:24576
ds_read_b128 v[44:47], v10 offset:25600
s_waitcnt lgkmcnt(0)
v_add_f32 v16, v16, v24
v_add_f32 v17, v17, v25
v_add_f32 v18, v18, v26
v_add_f32 v19, v19, v27
v_add_f32 v20, v20, v28
v_add_f32 v21, v21, v29
v_add_f32 v22, v22, v30
v_add_f32 v23, v23, v31
v_add_f32 v16, v16, v32
v_add_f32 v17, v17, v33
v_add_f32 v18, v18, v34
v_add_f32 v19, v19, v35
v_add_f32 v20, v20, v36
v_add_f32 v21, v21, v37
v_add_f32 v22, v22, v38
v_add_f32 v23, v23, v39
v_add_f32 v16, v16, v40
v_add_f32 v17, v17, v41
v_add_f32 v18, v18, v42
v_add_f32 v19, v19, v43
v_add_f32 v20, v20, v44
v_add_f32 v21, v21, v45
v_add_f32 v22, v22, v46
v_add_f32 v23, v23, v47
v_cvt_pk_bf16_f32 v60, v16, v17
v_cvt_pk_bf16_f32 v61, v18, v19
v_cvt_pk_bf16_f32 v62, v20, v21
v_cvt_pk_bf16_f32 v63, v22, v23
s_lshr_b32 s50, s40, 1
s_lshl_b32 s50, s50, 5
s_lshl_b32 s51, s42, 6
s_add_u32 s50, s50, s51
v_add_u32 v10, s50, v8
v_lshlrev_b32 v10, 10, v10
v_lshl_add_u32 v10, v9, 3, v10
s_and_b32 s50, s40, 1
s_lshl_b32 s50, s50, 5
s_lshl_b32 s51, s41, 6
s_add_u32 s50, s50, s51
buffer_store_dwordx2 v[60:61], v10, s[20:23], s50 offen
buffer_store_dwordx2 v[62:63], v10, s[20:23], s50 offen offset:16
B_end:
s_endpgm
.section .rodata,"a"
.p2align 6
.amdhsa_kernel oproj_kernel
  .amdhsa_next_free_vgpr 256
  .amdhsa_next_free_sgpr 102
  .amdhsa_accum_offset 256
  .amdhsa_group_segment_fixed_size 0
  .amdhsa_kernarg_size 64
  .amdhsa_user_sgpr_count 2
  .amdhsa_user_sgpr_kernarg_segment_ptr 1
  .amdhsa_system_sgpr_workgroup_id_x 1
.end_amdhsa_kernel
.text
```
